```python
import torch

def _softmax(x, axis=-1):
    return torch.softmax(x, dim=axis)
def _gelu(x):
    return torch.nn.functional.gelu(x, approximate="tanh")
def _silu(x):
    return torch.nn.functional.silu(x)
def _sigmoid(x):
    return torch.sigmoid(x)
def _layernorm(x, axis=-1, eps=1e-5):
    m = x.mean(dim=axis, keepdim=True)
    v = x.var(dim=axis, keepdim=True, unbiased=False)
    return (x - m) / torch.sqrt(v + eps)
def _scatter_add(tgt, idx, src, axis=0):
    return tgt.clone().index_add_(axis, idx, src)
def _segment_sum(src, seg, n):
    out = torch.zeros((n,) + src.shape[1:], dtype=src.dtype)
    return out.index_add_(0, seg, src)
def _pad(x, pw):
    flat = tuple(v for pair in reversed(pw) for v in pair)
    return torch.nn.functional.pad(x, flat)

kernel_name = 'standalone__depthwise_separable__vision'

def setup_inputs():

    _w = (lambda a: (lambda t: t.to(torch.bfloat16) if t.is_floating_point() else t)(torch.as_tensor(a)))
    H = W = 384
    C = 192
    k = 1
    return {
        "x": _w((lambda *s: torch.randn(*s, dtype=torch.bfloat16) * 0.05)(1, H, W, C)),
        "dw": _w((lambda *s: torch.randn(*s, dtype=torch.bfloat16) * 0.05)(k, k, C)),
        "pw": _w((lambda *s: torch.randn(*s, dtype=torch.bfloat16) * 0.05)(C, C)),
    }

def reference(x, dw, pw):
    B, H, W, C = x.shape
    k = dw.shape[0]
    pad = k // 2
    xp = _pad(x, ((0,0),(pad,pad),(pad,pad),(0,0)))
    out = torch.zeros_like(x)
    for i in range(k):
        for j in range(k):
            out = out + xp[:, i:i+H, j:j+W, :] * dw[i, j][None, None, None, :]
    return torch.einsum('bhwc,cd->bhwd', out, pw)
```

```asm
; @launch grid=(256,1,1) block=(256,1,1) lds=122880
.amdgcn_target "amdgcn-amd-amdhsa--gfx950"
.text
.globl standalone__depthwise_separable__vision_kernel
.p2align 8
.type standalone__depthwise_separable__vision_kernel,@function
standalone__depthwise_separable__vision_kernel:
  s_cmp_ge_u32 s2, 256
  s_cbranch_scc1 L_end
  s_load_dwordx8 s[28:35], s[0:1], 0
  s_load_dwordx2 s[68:69], s[0:1], 32
  v_lshrrev_b32 v1, 6, v0
  v_and_b32 v0, 63, v0
  v_readfirstlane_b32 s20, v1
  v_and_b32 v2, 15, v0
  v_lshrrev_b32 v3, 4, v0
  s_lshr_b32 s47, s2, 3
  s_getpc_b64 s[74:75]
L_pc:
  s_lshl_b32 s27, s47, 2
  s_add_u32 s27, s27, s20
  s_and_b32 s27, s27, 15
  s_lshl_b32 s27, s27, 10
  v_lshl_add_u32 v4, v0, 4, s27
  v_min_u32 v4, L_codeend-L_pc-16, v4
  global_load_dwordx4 v[58:61], v4, s[74:75]
  s_movk_i32 s44, 0x180
  v_mul_u32_u24 v5, 0xc00, v3
  v_lshl_add_u32 v214, v2, 4, v5
  v_lshl_add_u32 v215, v2, 3, v5
  v_add_u32 v215, 0x100, v215
  v_lshlrev_b32 v216, 4, v3
  s_mul_i32 s64, s20, 12288
  s_lshl_b32 s65, s20, 6
  s_mov_b32 s7, 0x20000
  s_mov_b32 s11, 0x20000
  s_mov_b32 s15, 0x20000
  s_mov_b32 s19, 0x20000
  s_mov_b32 s6, 56623104
  s_mov_b32 s10, 56623104
  s_mov_b32 s14, 73728
  s_mov_b32 s18, 384
  s_getreg_b32 s58, hwreg(HW_REG_XCC_ID, 0, 3)
  s_and_b32 s72, s47, 3
  s_lshr_b32 s27, s47, 3
  s_lshl_b32 s27, s27, 2
  s_add_u32 s72, s72, s27
  s_lshl_b32 s72, s72, 1
  s_add_u32 s72, s72, s58
  s_and_b32 s27, s47, 4
  s_or_b32 s27, s27, s20
  s_lshr_b32 s45, s58, 1
  s_or_b32 s27, s27, s45
  s_cmp_lg_u32 s27, 0
  s_cselect_b32 s72, 14, s72
  s_waitcnt lgkmcnt(0)
  s_mov_b32 s12, s32
  s_and_b32 s13, s33, 0xffff
  s_mov_b32 s16, s30
  s_and_b32 s17, s31, 0xffff
  s_mov_b32 s4, s28
  s_and_b32 s5, s29, 0xffff
  s_mov_b32 s8, s34
  s_and_b32 s9, s35, 0xffff
  s_add_u32 s36, s68, 0
  s_addc_u32 s37, s69, 0
  s_cmp_ge_u32 s72, 14
  s_cbranch_scc1 L_noprobe1
  s_lshl_b32 s27, s72, 22
  s_add_u32 s27, s27, 1065728
  s_add_u32 s62, s28, s27
  s_addc_u32 s63, s29, 0
  s_and_b32 s74, s72, 1
  s_lshl_b32 s56, s74, 13
  s_xor_b32 s57, s56, 0x2000
  s_load_dword s60, s[62:63], s56 glc
  s_load_dword s61, s[62:63], s57 glc
L_noprobe1:
  buffer_load_dwordx4 v[120:123], v216, s[16:19], s65 offen
  buffer_load_dwordx4 v[72:75], v214, s[12:15], s64 offen offset:0
  buffer_load_dwordx2 v[104:105], v215, s[12:15], s64 offen offset:0
  buffer_load_dwordx4 v[76:79], v214, s[12:15], s64 offen offset:384
  buffer_load_dwordx2 v[106:107], v215, s[12:15], s64 offen offset:384
  s_cmp_ge_u32 s72, 14
  s_cbranch_scc1 L_noprobe2
  s_waitcnt lgkmcnt(1)
  s_getreg_b32 s27, hwreg(HW_REG_IB_STS, 8, 4)
  s_cmp_eq_u32 s27, 0
  s_cselect_b32 s27, 1, 0
  s_xor_b32 s74, s74, s27
  s_branch L_probe_more
L_noprobe2:
  buffer_load_dwordx4 v[80:83], v214, s[12:15], s64 offen offset:768
  s_lshr_b32 s27, s20, 1
  s_add_u32 s27, s27, 4
  s_and_b32 s45, s20, 1
  s_lshl_b32 s66, s27, 3
  s_add_u32 s66, s66, s45
  s_lshl_b32 s67, s66, 3
  s_mul_i32 s66, s66, 1536
  s_lshl_b32 s46, s47, 2
  s_and_b32 s27, s2, 3
  s_add_u32 s46, s46, s27
  buffer_load_dwordx2 v[108:109], v215, s[12:15], s64 offen offset:768
  s_lshr_b32 s27, s46, 6
  s_and_b32 s45, s46, 63
  s_add_u32 s43, s27, 0
  s_and_b32 s43, s43, 1
  s_mul_i32 s43, s43, 576
  s_add_u32 s43, s43, s45
  s_mul_i32 s22, s43, 49152
  s_add_u32 s43, s27, 1
  s_and_b32 s43, s43, 1
  s_mul_i32 s43, s43, 576
  buffer_load_dwordx4 v[84:87], v214, s[12:15], s64 offen offset:1152
  s_add_u32 s43, s43, s45
  s_mul_i32 s21, s43, 49152
  s_lshr_b32 s38, s2, 2
  s_xor_b32 s38, s38, s20
  s_and_b32 s38, s38, 1
  s_mov_b32 s39, 0
  s_mov_b32 s40, 0x0fffc000
  s_mul_i32 s25, s20, 12288
  s_add_u32 s25, s25, 73728
  s_mov_b32 s26, 0xffff0000
  buffer_load_dwordx2 v[110:111], v215, s[12:15], s64 offen offset:1152
  s_lshl_b32 s45, s20, 3
  s_lshr_b32 s41, 0x5b361000, s45
  s_and_b32 s41, s41, 0xff
  s_lshr_b32 s42, 0x5b300500, s45
  s_and_b32 s42, s42, 0xff
  s_lshr_b32 s59, 0x00151600, s45
  s_and_b32 s59, s59, 0xff
  s_movk_i32 s27, 2731
  v_mul_u32_u24 v5, s27, v0
  v_lshrrev_b32 v8, 16, v5
  buffer_load_dwordx4 v[88:91], v214, s[12:15], s64 offen offset:1536
  v_bfe_u32 v5, v5, 17, 3
  v_mul_u32_u24 v9, 24, v8
  v_sub_u32 v9, v0, v9
  v_xor_b32 v9, v9, v5
  v_lshlrev_b32 v16, 4, v9
  v_xor_b32 v19, 64, v16
  v_add_u32 v8, s41, v8
  v_subrev_u32 v6, s42, v8
  v_lshrrev_b32 v6, 4, v6
  v_mad_u32_u24 v10, v6, s59, v8
  buffer_load_dwordx2 v[112:113], v215, s[12:15], s64 offen offset:1536
  v_add_u32 v8, 8, v8
  v_subrev_u32 v6, s42, v8
  v_lshrrev_b32 v6, 4, v6
  v_mad_u32_u24 v13, v6, s59, v8
  v_add_u32 v4, 64, v0
  v_mul_u32_u24 v5, s27, v4
  v_lshrrev_b32 v8, 16, v5
  v_bfe_u32 v5, v5, 17, 3
  v_mul_u32_u24 v9, 24, v8
  v_sub_u32 v9, v4, v9
  buffer_load_dwordx4 v[92:95], v214, s[12:15], s64 offen offset:1920
  v_xor_b32 v9, v9, v5
  v_lshlrev_b32 v17, 4, v9
  v_xor_b32 v20, 64, v17
  v_add_u32 v8, s41, v8
  v_subrev_u32 v6, s42, v8
  v_lshrrev_b32 v6, 4, v6
  v_mad_u32_u24 v11, v6, s59, v8
  v_add_u32 v8, 8, v8
  v_subrev_u32 v6, s42, v8
  v_lshrrev_b32 v6, 4, v6
  buffer_load_dwordx2 v[114:115], v215, s[12:15], s64 offen offset:1920
  v_mad_u32_u24 v14, v6, s59, v8
  v_add_u32 v4, 128, v0
  v_mul_u32_u24 v5, s27, v4
  v_lshrrev_b32 v8, 16, v5
  v_bfe_u32 v5, v5, 17, 3
  v_mul_u32_u24 v9, 24, v8
  v_sub_u32 v9, v4, v9
  v_xor_b32 v9, v9, v5
  v_lshlrev_b32 v18, 4, v9
  v_xor_b32 v21, 64, v18
  buffer_load_dwordx4 v[96:99], v214, s[12:15], s64 offen offset:2304
  v_add_u32 v8, s41, v8
  v_subrev_u32 v6, s42, v8
  v_lshrrev_b32 v6, 4, v6
  v_mad_u32_u24 v12, v6, s59, v8
  v_add_u32 v8, 8, v8
  v_subrev_u32 v6, s42, v8
  v_lshrrev_b32 v6, 4, v6
  v_mad_u32_u24 v15, v6, s59, v8
  v_lshlrev_b32 v217, 4, v0
  v_lshrrev_b32 v4, 1, v2
  buffer_load_dwordx2 v[116:117], v215, s[12:15], s64 offen offset:2304
  v_xor_b32 v4, v4, v3
  v_lshlrev_b32 v4, 4, v4
  v_mad_u32_u24 v30, v2, s44, v4
  v_xor_b32 v4, 64, v4
  v_mad_u32_u24 v31, v2, s44, v4
  v_add_u32 v30, s25, v30
  v_add_u32 v31, s25, v31
  v_lshl_add_u32 v8, v3, 2, s41
  v_subrev_u32 v6, s42, v8
  v_lshrrev_b32 v6, 4, v6
  buffer_load_dwordx4 v[100:103], v214, s[12:15], s64 offen offset:2688
  v_mad_u32_u24 v22, v6, s59, v8
  v_add_u32 v8, 1, v8
  v_subrev_u32 v6, s42, v8
  v_lshrrev_b32 v6, 4, v6
  v_mad_u32_u24 v23, v6, s59, v8
  v_add_u32 v8, 1, v8
  v_subrev_u32 v6, s42, v8
  v_lshrrev_b32 v6, 4, v6
  v_mad_u32_u24 v24, v6, s59, v8
  v_add_u32 v8, 1, v8
  buffer_load_dwordx2 v[118:119], v215, s[12:15], s64 offen offset:2688
  v_subrev_u32 v6, s42, v8
  v_lshrrev_b32 v6, 4, v6
  v_mad_u32_u24 v25, v6, s59, v8
  v_lshlrev_b32 v26, 4, v2
  v_lshlrev_b32 v27, 3, v2
  v_sub_u32 v27, 0x100, v27
  s_load_dword s73, s[36:37], 0x80
  s_mul_i32 s27, s20, 12288
  v_add_u32 v218, s27, v217
  s_waitcnt vmcnt(12)
  v_lshlrev_b32 v150, 16, v120
  v_and_b32 v151, s26, v120
  v_lshlrev_b32 v158, 16, v72
  v_lshlrev_b32 v159, 16, v76
  v_and_b32 v160, s26, v72
  v_and_b32 v161, s26, v76
  v_pk_mul_f32 v[158:159], v[158:159], v[150:151]
  v_pk_mul_f32 v[160:161], v[160:161], v[150:151]
  v_cvt_pk_bf16_f32 v166, v158, v159
  v_cvt_pk_bf16_f32 v170, v160, v161
  buffer_load_dwordx2 v[148:149], v216, s[16:19], s67 offen
  v_lshlrev_b32 v162, 16, v73
  v_lshlrev_b32 v163, 16, v77
  v_and_b32 v164, s26, v73
  v_and_b32 v165, s26, v77
  v_pk_mul_f32 v[162:163], v[162:163], v[150:151]
  v_pk_mul_f32 v[164:165], v[164:165], v[150:151]
  v_cvt_pk_bf16_f32 v174, v162, v163
  v_cvt_pk_bf16_f32 v178, v164, v165
  buffer_load_dwordx4 v[124:127], v214, s[12:15], s66 offen offset:0
  v_lshlrev_b32 v158, 16, v74
  v_lshlrev_b32 v159, 16, v78
  v_and_b32 v160, s26, v74
  v_and_b32 v161, s26, v78
  v_pk_mul_f32 v[158:159], v[158:159], v[150:151]
  v_pk_mul_f32 v[160:161], v[160:161], v[150:151]
  v_cvt_pk_bf16_f32 v182, v158, v159
  v_cvt_pk_bf16_f32 v186, v160, v161
  v_lshlrev_b32 v162, 16, v75
  v_lshlrev_b32 v163, 16, v79
  v_and_b32 v164, s26, v75
  v_and_b32 v165, s26, v79
  v_pk_mul_f32 v[162:163], v[162:163], v[150:151]
  v_pk_mul_f32 v[164:165], v[164:165], v[150:151]
  v_cvt_pk_bf16_f32 v190, v162, v163
  v_cvt_pk_bf16_f32 v194, v164, v165
  buffer_load_dwordx2 v[140:141], v215, s[12:15], s66 offen offset:0
  v_lshlrev_b32 v158, 16, v104
  v_lshlrev_b32 v159, 16, v106
  v_and_b32 v160, s26, v104
  v_and_b32 v161, s26, v106
  v_pk_mul_f32 v[158:159], v[158:159], v[150:151]
  v_pk_mul_f32 v[160:161], v[160:161], v[150:151]
  v_cvt_pk_bf16_f32 v198, v158, v159
  v_cvt_pk_bf16_f32 v202, v160, v161
  buffer_load_dwordx4 v[128:131], v214, s[12:15], s66 offen offset:384
  v_lshlrev_b32 v162, 16, v105
  v_lshlrev_b32 v163, 16, v107
  v_and_b32 v164, s26, v105
  v_and_b32 v165, s26, v107
  v_pk_mul_f32 v[162:163], v[162:163], v[150:151]
  v_pk_mul_f32 v[164:165], v[164:165], v[150:151]
  v_cvt_pk_bf16_f32 v206, v162, v163
  v_cvt_pk_bf16_f32 v210, v164, v165
  s_waitcnt vmcnt(12)
  v_lshlrev_b32 v152, 16, v121
  v_and_b32 v153, s26, v121
  v_lshlrev_b32 v158, 16, v80
  v_lshlrev_b32 v159, 16, v84
  v_and_b32 v160, s26, v80
  v_and_b32 v161, s26, v84
  v_pk_mul_f32 v[158:159], v[158:159], v[152:153]
  v_pk_mul_f32 v[160:161], v[160:161], v[152:153]
  v_cvt_pk_bf16_f32 v167, v158, v159
  v_cvt_pk_bf16_f32 v171, v160, v161
  buffer_load_dwordx2 v[142:143], v215, s[12:15], s66 offen offset:384
  v_lshlrev_b32 v162, 16, v81
  v_lshlrev_b32 v163, 16, v85
  v_and_b32 v164, s26, v81
  v_and_b32 v165, s26, v85
  v_pk_mul_f32 v[162:163], v[162:163], v[152:153]
  v_pk_mul_f32 v[164:165], v[164:165], v[152:153]
  v_cvt_pk_bf16_f32 v175, v162, v163
  v_cvt_pk_bf16_f32 v179, v164, v165
  v_lshlrev_b32 v158, 16, v82
  v_lshlrev_b32 v159, 16, v86
  v_and_b32 v160, s26, v82
  v_and_b32 v161, s26, v86
  v_pk_mul_f32 v[158:159], v[158:159], v[152:153]
  v_pk_mul_f32 v[160:161], v[160:161], v[152:153]
  v_cvt_pk_bf16_f32 v183, v158, v159
  v_cvt_pk_bf16_f32 v187, v160, v161
  buffer_load_dwordx4 v[132:135], v214, s[12:15], s66 offen offset:768
  v_lshlrev_b32 v162, 16, v83
  v_lshlrev_b32 v163, 16, v87
  v_and_b32 v164, s26, v83
  v_and_b32 v165, s26, v87
  v_pk_mul_f32 v[162:163], v[162:163], v[152:153]
  v_pk_mul_f32 v[164:165], v[164:165], v[152:153]
  v_cvt_pk_bf16_f32 v191, v162, v163
  v_cvt_pk_bf16_f32 v195, v164, v165
  buffer_load_dwordx2 v[144:145], v215, s[12:15], s66 offen offset:768
  v_lshlrev_b32 v158, 16, v108
  v_lshlrev_b32 v159, 16, v110
  v_and_b32 v160, s26, v108
  v_and_b32 v161, s26, v110
  v_pk_mul_f32 v[158:159], v[158:159], v[152:153]
  v_pk_mul_f32 v[160:161], v[160:161], v[152:153]
  v_cvt_pk_bf16_f32 v199, v158, v159
  v_cvt_pk_bf16_f32 v203, v160, v161
  v_lshlrev_b32 v162, 16, v109
  v_lshlrev_b32 v163, 16, v111
  v_and_b32 v164, s26, v109
  v_and_b32 v165, s26, v111
  v_pk_mul_f32 v[162:163], v[162:163], v[152:153]
  v_pk_mul_f32 v[164:165], v[164:165], v[152:153]
  v_cvt_pk_bf16_f32 v207, v162, v163
  v_cvt_pk_bf16_f32 v211, v164, v165
  buffer_load_dwordx4 v[136:139], v214, s[12:15], s66 offen offset:1152
  s_waitcnt vmcnt(12)
  v_lshlrev_b32 v154, 16, v122
  v_and_b32 v155, s26, v122
  v_lshlrev_b32 v158, 16, v88
  v_lshlrev_b32 v159, 16, v92
  v_and_b32 v160, s26, v88
  v_and_b32 v161, s26, v92
  v_pk_mul_f32 v[158:159], v[158:159], v[154:155]
  v_pk_mul_f32 v[160:161], v[160:161], v[154:155]
  v_cvt_pk_bf16_f32 v168, v158, v159
  v_cvt_pk_bf16_f32 v172, v160, v161
  buffer_load_dwordx2 v[146:147], v215, s[12:15], s66 offen offset:1152
  v_lshlrev_b32 v162, 16, v89
  v_lshlrev_b32 v163, 16, v93
  v_and_b32 v164, s26, v89
  v_and_b32 v165, s26, v93
  v_pk_mul_f32 v[162:163], v[162:163], v[154:155]
  v_pk_mul_f32 v[164:165], v[164:165], v[154:155]
  v_cvt_pk_bf16_f32 v176, v162, v163
  v_cvt_pk_bf16_f32 v180, v164, v165
  v_lshlrev_b32 v158, 16, v90
  v_lshlrev_b32 v159, 16, v94
  v_and_b32 v160, s26, v90
  v_and_b32 v161, s26, v94
  v_pk_mul_f32 v[158:159], v[158:159], v[154:155]
  v_pk_mul_f32 v[160:161], v[160:161], v[154:155]
  v_cvt_pk_bf16_f32 v184, v158, v159
  v_cvt_pk_bf16_f32 v188, v160, v161
  s_add_u32 s48, s22, 0
  s_mul_i32 s52, s38, 127
  s_add_u32 m0, s25, 0
  v_xor_b32 v56, s52, v10
  v_mad_u32_u24 v56, v56, s44, v16
  buffer_load_dwordx4 v56, s[4:7], s48 offen nt lds
  v_lshlrev_b32 v162, 16, v91
  v_lshlrev_b32 v163, 16, v95
  v_and_b32 v164, s26, v91
  v_and_b32 v165, s26, v95
  v_pk_mul_f32 v[162:163], v[162:163], v[154:155]
  v_pk_mul_f32 v[164:165], v[164:165], v[154:155]
  v_cvt_pk_bf16_f32 v192, v162, v163
  v_cvt_pk_bf16_f32 v196, v164, v165
  v_lshlrev_b32 v158, 16, v112
  v_lshlrev_b32 v159, 16, v114
  v_and_b32 v160, s26, v112
  v_and_b32 v161, s26, v114
  v_pk_mul_f32 v[158:159], v[158:159], v[154:155]
  v_pk_mul_f32 v[160:161], v[160:161], v[154:155]
  v_cvt_pk_bf16_f32 v200, v158, v159
  v_cvt_pk_bf16_f32 v204, v160, v161
  s_add_u32 m0, s25, 1024
  v_xor_b32 v56, s52, v11
  v_mad_u32_u24 v56, v56, s44, v17
  buffer_load_dwordx4 v56, s[4:7], s48 offen nt lds
  v_lshlrev_b32 v162, 16, v113
  v_lshlrev_b32 v163, 16, v115
  v_and_b32 v164, s26, v113
  v_and_b32 v165, s26, v115
  v_pk_mul_f32 v[162:163], v[162:163], v[154:155]
  v_pk_mul_f32 v[164:165], v[164:165], v[154:155]
  v_cvt_pk_bf16_f32 v208, v162, v163
  v_cvt_pk_bf16_f32 v212, v164, v165
  s_add_u32 m0, s25, 2048
  v_xor_b32 v56, s52, v12
  v_mad_u32_u24 v56, v56, s44, v18
  buffer_load_dwordx4 v56, s[4:7], s48 offen nt lds
  s_waitcnt vmcnt(12)
  v_lshlrev_b32 v156, 16, v123
  v_and_b32 v157, s26, v123
  v_lshlrev_b32 v158, 16, v96
  v_lshlrev_b32 v159, 16, v100
  v_and_b32 v160, s26, v96
  v_and_b32 v161, s26, v100
  v_pk_mul_f32 v[158:159], v[158:159], v[156:157]
  v_pk_mul_f32 v[160:161], v[160:161], v[156:157]
  v_cvt_pk_bf16_f32 v169, v158, v159
  v_cvt_pk_bf16_f32 v173, v160, v161
  ds_write_b128 v218, v[166:169] offset:0
  ds_write_b128 v218, v[170:173] offset:1024
  v_lshlrev_b32 v162, 16, v97
  v_lshlrev_b32 v163, 16, v101
  v_and_b32 v164, s26, v97
  v_and_b32 v165, s26, v101
  v_pk_mul_f32 v[162:163], v[162:163], v[156:157]
  v_pk_mul_f32 v[164:165], v[164:165], v[156:157]
  v_cvt_pk_bf16_f32 v177, v162, v163
  v_cvt_pk_bf16_f32 v181, v164, v165
  ds_write_b128 v218, v[174:177] offset:2048
  ds_write_b128 v218, v[178:181] offset:3072
  s_add_u32 m0, s25, 3072
  v_xor_b32 v56, s52, v13
  v_mad_u32_u24 v56, v56, s44, v19
  buffer_load_dwordx4 v56, s[4:7], s48 offen nt lds
  v_lshlrev_b32 v158, 16, v98
  v_lshlrev_b32 v159, 16, v102
  v_and_b32 v160, s26, v98
  v_and_b32 v161, s26, v102
  v_pk_mul_f32 v[158:159], v[158:159], v[156:157]
  v_pk_mul_f32 v[160:161], v[160:161], v[156:157]
  v_cvt_pk_bf16_f32 v185, v158, v159
  v_cvt_pk_bf16_f32 v189, v160, v161
  ds_write_b128 v218, v[182:185] offset:4096
  ds_write_b128 v218, v[186:189] offset:5120
  s_add_u32 m0, s25, 4096
  v_xor_b32 v56, s52, v14
  v_mad_u32_u24 v56, v56, s44, v20
  buffer_load_dwordx4 v56, s[4:7], s48 offen nt lds
  v_lshlrev_b32 v162, 16, v99
  v_lshlrev_b32 v163, 16, v103
  v_and_b32 v164, s26, v99
  v_and_b32 v165, s26, v103
  v_pk_mul_f32 v[162:163], v[162:163], v[156:157]
  v_pk_mul_f32 v[164:165], v[164:165], v[156:157]
  v_cvt_pk_bf16_f32 v193, v162, v163
  v_cvt_pk_bf16_f32 v197, v164, v165
  ds_write_b128 v218, v[190:193] offset:6144
  ds_write_b128 v218, v[194:197] offset:7168
  v_lshlrev_b32 v158, 16, v116
  v_lshlrev_b32 v159, 16, v118
  v_and_b32 v160, s26, v116
  v_and_b32 v161, s26, v118
  v_pk_mul_f32 v[158:159], v[158:159], v[156:157]
  v_pk_mul_f32 v[160:161], v[160:161], v[156:157]
  v_cvt_pk_bf16_f32 v201, v158, v159
  v_cvt_pk_bf16_f32 v205, v160, v161
  ds_write_b128 v218, v[198:201] offset:8192
  ds_write_b128 v218, v[202:205] offset:9216
  s_add_u32 m0, s25, 5120
  v_xor_b32 v56, s52, v15
  v_mad_u32_u24 v56, v56, s44, v21
  buffer_load_dwordx4 v56, s[4:7], s48 offen nt lds
  v_lshlrev_b32 v162, 16, v117
  v_lshlrev_b32 v163, 16, v119
  v_and_b32 v164, s26, v117
  v_and_b32 v165, s26, v119
  v_pk_mul_f32 v[162:163], v[162:163], v[156:157]
  v_pk_mul_f32 v[164:165], v[164:165], v[156:157]
  v_cvt_pk_bf16_f32 v209, v162, v163
  v_cvt_pk_bf16_f32 v213, v164, v165
  ds_write_b128 v218, v[206:209] offset:10240
  ds_write_b128 v218, v[210:213] offset:11264
  s_lshr_b32 s27, s20, 1
  s_add_u32 s27, s27, 4
  s_mul_i32 s27, s27, 12288
  s_and_b32 s45, s20, 1
  s_lshl_b32 s45, s45, 3
  s_add_u32 s27, s27, s45
  v_add_u32 v218, s27, v217
  s_waitcnt vmcnt(10)
  v_lshlrev_b32 v150, 16, v148
  v_and_b32 v151, s26, v148
  v_lshlrev_b32 v158, 16, v124
  v_lshlrev_b32 v159, 16, v128
  v_and_b32 v160, s26, v124
  v_and_b32 v161, s26, v128
  v_pk_mul_f32 v[158:159], v[158:159], v[150:151]
  v_pk_mul_f32 v[160:161], v[160:161], v[150:151]
  v_cvt_pk_bf16_f32 v166, v158, v159
  v_cvt_pk_bf16_f32 v170, v160, v161
  s_add_u32 s49, s21, 3145728
  s_mul_i32 s53, s38, 127
  s_add_u32 m0, s25, 6144
  v_xor_b32 v56, s53, v10
  v_mad_u32_u24 v56, v56, s44, v16
  buffer_load_dwordx4 v56, s[4:7], s49 offen nt lds
  v_lshlrev_b32 v162, 16, v125
  v_lshlrev_b32 v163, 16, v129
  v_and_b32 v164, s26, v125
  v_and_b32 v165, s26, v129
  v_pk_mul_f32 v[162:163], v[162:163], v[150:151]
  v_pk_mul_f32 v[164:165], v[164:165], v[150:151]
  v_cvt_pk_bf16_f32 v174, v162, v163
  v_cvt_pk_bf16_f32 v178, v164, v165
  v_lshlrev_b32 v158, 16, v126
  v_lshlrev_b32 v159, 16, v130
  v_and_b32 v160, s26, v126
  v_and_b32 v161, s26, v130
  v_pk_mul_f32 v[158:159], v[158:159], v[150:151]
  v_pk_mul_f32 v[160:161], v[160:161], v[150:151]
  v_cvt_pk_bf16_f32 v182, v158, v159
  v_cvt_pk_bf16_f32 v186, v160, v161
  v_lshlrev_b32 v162, 16, v127
  v_lshlrev_b32 v163, 16, v131
  v_and_b32 v164, s26, v127
  v_and_b32 v165, s26, v131
  v_pk_mul_f32 v[162:163], v[162:163], v[150:151]
  v_pk_mul_f32 v[164:165], v[164:165], v[150:151]
  v_cvt_pk_bf16_f32 v190, v162, v163
  v_cvt_pk_bf16_f32 v194, v164, v165
  v_lshlrev_b32 v158, 16, v140
  v_lshlrev_b32 v159, 16, v142
  v_and_b32 v160, s26, v140
  v_and_b32 v161, s26, v142
  v_pk_mul_f32 v[158:159], v[158:159], v[150:151]
  v_pk_mul_f32 v[160:161], v[160:161], v[150:151]
  v_cvt_pk_bf16_f32 v198, v158, v159
  v_cvt_pk_bf16_f32 v202, v160, v161
  s_add_u32 m0, s25, 7168
  v_xor_b32 v56, s53, v11
  v_mad_u32_u24 v56, v56, s44, v17
  buffer_load_dwordx4 v56, s[4:7], s49 offen nt lds
  v_lshlrev_b32 v162, 16, v141
  v_lshlrev_b32 v163, 16, v143
  v_and_b32 v164, s26, v141
  v_and_b32 v165, s26, v143
  v_pk_mul_f32 v[162:163], v[162:163], v[150:151]
  v_pk_mul_f32 v[164:165], v[164:165], v[150:151]
  v_cvt_pk_bf16_f32 v206, v162, v163
  v_cvt_pk_bf16_f32 v210, v164, v165
  s_waitcnt vmcnt(8)
  v_lshlrev_b32 v152, 16, v149
  v_and_b32 v153, s26, v149
  v_lshlrev_b32 v158, 16, v132
  v_lshlrev_b32 v159, 16, v136
  v_and_b32 v160, s26, v132
  v_and_b32 v161, s26, v136
  v_pk_mul_f32 v[158:159], v[158:159], v[152:153]
  v_pk_mul_f32 v[160:161], v[160:161], v[152:153]
  v_cvt_pk_bf16_f32 v167, v158, v159
  v_cvt_pk_bf16_f32 v171, v160, v161
  ds_write_b64 v218, v[166:167] offset:0
  ds_write_b64 v218, v[170:171] offset:1024
  v_lshlrev_b32 v162, 16, v133
  v_lshlrev_b32 v163, 16, v137
  v_and_b32 v164, s26, v133
  v_and_b32 v165, s26, v137
  v_pk_mul_f32 v[162:163], v[162:163], v[152:153]
  v_pk_mul_f32 v[164:165], v[164:165], v[152:153]
  v_cvt_pk_bf16_f32 v175, v162, v163
  v_cvt_pk_bf16_f32 v179, v164, v165
  ds_write_b64 v218, v[174:175] offset:2048
  ds_write_b64 v218, v[178:179] offset:3072
  v_lshlrev_b32 v158, 16, v134
  v_lshlrev_b32 v159, 16, v138
  v_and_b32 v160, s26, v134
  v_and_b32 v161, s26, v138
  v_pk_mul_f32 v[158:159], v[158:159], v[152:153]
  v_pk_mul_f32 v[160:161], v[160:161], v[152:153]
  v_cvt_pk_bf16_f32 v183, v158, v159
  v_cvt_pk_bf16_f32 v187, v160, v161
  ds_write_b64 v218, v[182:183] offset:4096
  ds_write_b64 v218, v[186:187] offset:5120
  s_add_u32 m0, s25, 8192
  v_xor_b32 v56, s53, v12
  v_mad_u32_u24 v56, v56, s44, v18
  buffer_load_dwordx4 v56, s[4:7], s49 offen nt lds
  v_lshlrev_b32 v162, 16, v135
  v_lshlrev_b32 v163, 16, v139
  v_and_b32 v164, s26, v135
  v_and_b32 v165, s26, v139
  v_pk_mul_f32 v[162:163], v[162:163], v[152:153]
  v_pk_mul_f32 v[164:165], v[164:165], v[152:153]
  v_cvt_pk_bf16_f32 v191, v162, v163
  v_cvt_pk_bf16_f32 v195, v164, v165
  ds_write_b64 v218, v[190:191] offset:6144
  ds_write_b64 v218, v[194:195] offset:7168
  v_lshlrev_b32 v158, 16, v144
  v_lshlrev_b32 v159, 16, v146
  v_and_b32 v160, s26, v144
  v_and_b32 v161, s26, v146
  v_pk_mul_f32 v[158:159], v[158:159], v[152:153]
  v_pk_mul_f32 v[160:161], v[160:161], v[152:153]
  v_cvt_pk_bf16_f32 v199, v158, v159
  v_cvt_pk_bf16_f32 v203, v160, v161
  ds_write_b64 v218, v[198:199] offset:8192
  ds_write_b64 v218, v[202:203] offset:9216
  v_lshlrev_b32 v162, 16, v145
  v_lshlrev_b32 v163, 16, v147
  v_and_b32 v164, s26, v145
  v_and_b32 v165, s26, v147
  v_pk_mul_f32 v[162:163], v[162:163], v[152:153]
  v_pk_mul_f32 v[164:165], v[164:165], v[152:153]
  v_cvt_pk_bf16_f32 v207, v162, v163
  v_cvt_pk_bf16_f32 v211, v164, v165
  ds_write_b64 v218, v[206:207] offset:10240
  ds_write_b64 v218, v[210:211] offset:11264
L_join:
  v_add_u32 v218, 0x10000, v217
  s_waitcnt lgkmcnt(0)
  s_barrier
  ds_read_b128 a[0:3], v217 offset:0
  ds_read_b128 a[48:51], v217 offset:12288
  ds_read_b128 a[96:99], v217 offset:24576
  ds_read_b128 a[144:147], v217 offset:36864
  ds_read_b128 a[192:195], v217 offset:49152
  ds_read_b128 a[240:243], v217 offset:61440
  s_add_u32 m0, s25, 9216
  v_xor_b32 v56, s53, v13
  v_mad_u32_u24 v56, v56, s44, v19
  buffer_load_dwordx4 v56, s[4:7], s49 offen nt lds
  ds_read_b128 a[4:7], v217 offset:1024
  ds_read_b128 a[52:55], v217 offset:13312
  ds_read_b128 a[100:103], v217 offset:25600
  ds_read_b128 a[148:151], v217 offset:37888
  ds_read_b128 a[196:199], v217 offset:50176
  ds_read_b128 a[244:247], v217 offset:62464
  s_add_u32 m0, s25, 10240
  v_xor_b32 v56, s53, v14
  v_mad_u32_u24 v56, v56, s44, v20
  buffer_load_dwordx4 v56, s[4:7], s49 offen nt lds
  ds_read_b128 a[8:11], v217 offset:2048
  ds_read_b128 a[56:59], v217 offset:14336
  ds_read_b128 a[104:107], v217 offset:26624
  ds_read_b128 a[152:155], v217 offset:38912
  ds_read_b128 a[200:203], v217 offset:51200
  ds_read_b128 a[248:251], v217 offset:63488
  s_add_u32 m0, s25, 11264
  v_xor_b32 v56, s53, v15
  v_mad_u32_u24 v56, v56, s44, v21
  buffer_load_dwordx4 v56, s[4:7], s49 offen nt lds
  ds_read_b128 a[12:15], v217 offset:3072
  ds_read_b128 a[60:63], v217 offset:15360
  ds_read_b128 a[108:111], v217 offset:27648
  ds_read_b128 a[156:159], v217 offset:39936
  ds_read_b128 a[204:207], v217 offset:52224
  ds_read_b128 a[252:255], v217 offset:64512
  ds_read_b128 a[16:19], v217 offset:4096
  ds_read_b128 a[64:67], v217 offset:16384
  ds_read_b128 a[112:115], v217 offset:28672
  ds_read_b128 a[160:163], v217 offset:40960
  ds_read_b128 a[208:211], v217 offset:53248
  ds_read_b128 v[224:227], v218 offset:0
  ds_read_b128 a[20:23], v217 offset:5120
  ds_read_b128 a[68:71], v217 offset:17408
  ds_read_b128 a[116:119], v217 offset:29696
  ds_read_b128 a[164:167], v217 offset:41984
  ds_read_b128 a[212:215], v217 offset:54272
  ds_read_b128 v[228:231], v218 offset:1024
  ds_read_b128 a[24:27], v217 offset:6144
  ds_read_b128 a[72:75], v217 offset:18432
  ds_read_b128 a[120:123], v217 offset:30720
  ds_read_b128 a[168:171], v217 offset:43008
  ds_read_b128 a[216:219], v217 offset:55296
  ds_read_b128 v[232:235], v218 offset:2048
  ds_read_b128 a[28:31], v217 offset:7168
  ds_read_b128 a[76:79], v217 offset:19456
  ds_read_b128 a[124:127], v217 offset:31744
  ds_read_b128 a[172:175], v217 offset:44032
  ds_read_b128 a[220:223], v217 offset:56320
  ds_read_b128 v[236:239], v218 offset:3072
  ds_read_b128 a[32:35], v217 offset:8192
  ds_read_b128 a[80:83], v217 offset:20480
  ds_read_b128 a[128:131], v217 offset:32768
  ds_read_b128 a[176:179], v217 offset:45056
  ds_read_b128 a[224:227], v217 offset:57344
  ds_read_b128 v[240:243], v218 offset:4096
  ds_read_b128 a[36:39], v217 offset:9216
  ds_read_b128 a[84:87], v217 offset:21504
  ds_read_b128 a[132:135], v217 offset:33792
  ds_read_b128 a[180:183], v217 offset:46080
  ds_read_b128 a[228:231], v217 offset:58368
  ds_read_b128 v[244:247], v218 offset:5120
  s_waitcnt vmcnt(6)
  ds_read_b128 v[32:35], v30 offset:0
  ds_read_b128 v[36:39], v31 offset:0
  ds_read_b128 v[40:43], v30 offset:128
  ds_read_b128 v[44:47], v31 offset:128
  ds_read_b128 v[48:51], v30 offset:256
  ds_read_b128 v[52:55], v31 offset:256
  s_waitcnt lgkmcnt(5)
  v_mfma_f32_16x16x32_bf16 v[72:75], v[32:35], a[0:3], 0
  ds_read_b128 a[40:43], v217 offset:10240
  s_waitcnt lgkmcnt(5)
  v_mfma_f32_16x16x32_bf16 v[72:75], v[36:39], a[48:51], v[72:75]
  s_waitcnt lgkmcnt(4)
  v_mfma_f32_16x16x32_bf16 v[72:75], v[40:43], a[96:99], v[72:75]
  s_waitcnt lgkmcnt(3)
  v_mfma_f32_16x16x32_bf16 v[72:75], v[44:47], a[144:147], v[72:75]
  s_waitcnt lgkmcnt(2)
  v_mfma_f32_16x16x32_bf16 v[72:75], v[48:51], a[192:195], v[72:75]
  s_waitcnt lgkmcnt(1)
  v_mfma_f32_16x16x32_bf16 v[72:75], v[52:55], a[240:243], v[72:75]
  ds_read_b128 a[88:91], v217 offset:22528
  s_waitcnt lgkmcnt(7)
  v_mfma_f32_16x16x32_bf16 v[76:79], v[32:35], a[4:7], 0
  s_waitcnt lgkmcnt(6)
  v_mfma_f32_16x16x32_bf16 v[76:79], v[36:39], a[52:55], v[76:79]
  s_waitcnt lgkmcnt(5)
  v_mfma_f32_16x16x32_bf16 v[76:79], v[40:43], a[100:103], v[76:79]
  s_waitcnt lgkmcnt(4)
  v_mfma_f32_16x16x32_bf16 v[76:79], v[44:47], a[148:151], v[76:79]
  ds_read_b128 a[136:139], v217 offset:34816
  s_waitcnt lgkmcnt(4)
  v_mfma_f32_16x16x32_bf16 v[76:79], v[48:51], a[196:199], v[76:79]
  s_waitcnt lgkmcnt(3)
  v_mfma_f32_16x16x32_bf16 v[76:79], v[52:55], a[244:247], v[76:79]
  s_waitcnt lgkmcnt(8)
  v_mfma_f32_16x16x32_bf16 v[80:83], v[32:35], a[8:11], 0
  s_waitcnt lgkmcnt(7)
  v_mfma_f32_16x16x32_bf16 v[80:83], v[36:39], a[56:59], v[80:83]
  s_waitcnt lgkmcnt(6)
  v_mfma_f32_16x16x32_bf16 v[80:83], v[40:43], a[104:107], v[80:83]
  ds_read_b128 a[184:187], v217 offset:47104
  s_waitcnt lgkmcnt(6)
  v_mfma_f32_16x16x32_bf16 v[80:83], v[44:47], a[152:155], v[80:83]
  s_waitcnt lgkmcnt(5)
  v_mfma_f32_16x16x32_bf16 v[80:83], v[48:51], a[200:203], v[80:83]
  s_waitcnt lgkmcnt(4)
  v_mfma_f32_16x16x32_bf16 v[80:83], v[52:55], a[248:251], v[80:83]
  s_waitcnt lgkmcnt(9)
  v_mfma_f32_16x16x32_bf16 v[84:87], v[32:35], a[12:15], 0
  ds_read_b128 a[232:235], v217 offset:59392
  s_waitcnt lgkmcnt(9)
  v_mfma_f32_16x16x32_bf16 v[84:87], v[36:39], a[60:63], v[84:87]
  v_cvt_pk_bf16_f32 v120, v72, v76
  s_waitcnt lgkmcnt(8)
  v_mfma_f32_16x16x32_bf16 v[84:87], v[40:43], a[108:111], v[84:87]
  v_cvt_pk_bf16_f32 v124, v73, v77
  s_waitcnt lgkmcnt(7)
  v_mfma_f32_16x16x32_bf16 v[84:87], v[44:47], a[156:159], v[84:87]
  v_cvt_pk_bf16_f32 v128, v74, v78
  s_waitcnt lgkmcnt(6)
  v_mfma_f32_16x16x32_bf16 v[84:87], v[48:51], a[204:207], v[84:87]
  v_cvt_pk_bf16_f32 v132, v75, v79
  s_waitcnt lgkmcnt(5)
  v_mfma_f32_16x16x32_bf16 v[84:87], v[52:55], a[252:255], v[84:87]
  ds_read_b128 v[248:251], v218 offset:6144
  s_waitcnt lgkmcnt(11)
  v_mfma_f32_16x16x32_bf16 v[88:91], v[32:35], a[16:19], 0
  s_waitcnt lgkmcnt(10)
  v_mfma_f32_16x16x32_bf16 v[88:91], v[36:39], a[64:67], v[88:91]
  v_xor_b32 v57, s52, v22
  v_mad_u32_u24 v62, v57, s44, v26
  v_add_u32 v66, v62, v27
  s_waitcnt lgkmcnt(9)
  v_mfma_f32_16x16x32_bf16 v[88:91], v[40:43], a[112:115], v[88:91]
  v_xor_b32 v57, s52, v23
  v_mad_u32_u24 v63, v57, s44, v26
  v_add_u32 v67, v63, v27
  s_waitcnt lgkmcnt(8)
  v_mfma_f32_16x16x32_bf16 v[88:91], v[44:47], a[160:163], v[88:91]
  ds_read_b128 a[44:47], v217 offset:11264
  v_xor_b32 v57, s52, v24
  v_mad_u32_u24 v64, v57, s44, v26
  v_add_u32 v68, v64, v27
  s_waitcnt lgkmcnt(8)
  v_mfma_f32_16x16x32_bf16 v[88:91], v[48:51], a[208:211], v[88:91]
  v_xor_b32 v57, s52, v25
  v_mad_u32_u24 v65, v57, s44, v26
  v_add_u32 v69, v65, v27
  s_waitcnt lgkmcnt(7)
  v_mfma_f32_16x16x32_bf16 v[88:91], v[52:55], v[224:227], v[88:91]
  s_load_dwordx16 s[84:99], s[36:37], 0x0
  s_waitcnt lgkmcnt(12)
  v_mfma_f32_16x16x32_bf16 v[92:95], v[32:35], a[20:23], 0
  s_waitcnt lgkmcnt(11)
  v_mfma_f32_16x16x32_bf16 v[92:95], v[36:39], a[68:71], v[92:95]
  v_cvt_pk_bf16_f32 v121, v80, v84
  s_waitcnt lgkmcnt(10)
  v_mfma_f32_16x16x32_bf16 v[92:95], v[40:43], a[116:119], v[92:95]
  ds_read_b128 a[92:95], v217 offset:23552
  v_cvt_pk_bf16_f32 v125, v81, v85
  s_waitcnt lgkmcnt(10)
  v_mfma_f32_16x16x32_bf16 v[92:95], v[44:47], a[164:167], v[92:95]
  v_cvt_pk_bf16_f32 v129, v82, v86
  s_waitcnt lgkmcnt(9)
  v_mfma_f32_16x16x32_bf16 v[92:95], v[48:51], a[212:215], v[92:95]
  v_cvt_pk_bf16_f32 v133, v83, v87
  s_waitcnt lgkmcnt(8)
  v_mfma_f32_16x16x32_bf16 v[92:95], v[52:55], v[228:231], v[92:95]
  s_waitcnt lgkmcnt(13)
  v_mfma_f32_16x16x32_bf16 v[96:99], v[32:35], a[24:27], 0
  ds_read_b128 a[140:143], v217 offset:35840
  s_waitcnt lgkmcnt(13)
  v_mfma_f32_16x16x32_bf16 v[96:99], v[36:39], a[72:75], v[96:99]
  s_waitcnt lgkmcnt(12)
  v_mfma_f32_16x16x32_bf16 v[96:99], v[40:43], a[120:123], v[96:99]
  s_waitcnt lgkmcnt(11)
  v_mfma_f32_16x16x32_bf16 v[96:99], v[44:47], a[168:171], v[96:99]
  s_waitcnt lgkmcnt(10)
  v_mfma_f32_16x16x32_bf16 v[96:99], v[48:51], a[216:219], v[96:99]
  s_waitcnt lgkmcnt(9)
  v_mfma_f32_16x16x32_bf16 v[96:99], v[52:55], v[232:235], v[96:99]
  ds_read_b128 a[188:191], v217 offset:48128
  s_waitcnt lgkmcnt(15)
  v_mfma_f32_16x16x32_bf16 v[100:103], v[32:35], a[28:31], 0
  s_waitcnt lgkmcnt(14)
  v_mfma_f32_16x16x32_bf16 v[100:103], v[36:39], a[76:79], v[100:103]
  v_cvt_pk_bf16_f32 v122, v88, v92
  s_waitcnt lgkmcnt(13)
  v_mfma_f32_16x16x32_bf16 v[100:103], v[40:43], a[124:127], v[100:103]
  v_cvt_pk_bf16_f32 v126, v89, v93
  s_waitcnt lgkmcnt(12)
  v_mfma_f32_16x16x32_bf16 v[100:103], v[44:47], a[172:175], v[100:103]
  ds_read_b128 a[236:239], v217 offset:60416
  v_cvt_pk_bf16_f32 v130, v90, v94
  s_waitcnt lgkmcnt(12)
  v_mfma_f32_16x16x32_bf16 v[100:103], v[48:51], a[220:223], v[100:103]
  v_cvt_pk_bf16_f32 v134, v91, v95
  s_waitcnt lgkmcnt(11)
  v_mfma_f32_16x16x32_bf16 v[100:103], v[52:55], v[236:239], v[100:103]
  s_waitcnt lgkmcnt(15)
  v_mfma_f32_16x16x32_bf16 v[104:107], v[32:35], a[32:35], 0
  s_waitcnt lgkmcnt(15)
  v_mfma_f32_16x16x32_bf16 v[104:107], v[36:39], a[80:83], v[104:107]
  s_waitcnt lgkmcnt(14)
  v_mfma_f32_16x16x32_bf16 v[104:107], v[40:43], a[128:131], v[104:107]
  ds_read_b128 v[252:255], v218 offset:7168
  s_waitcnt lgkmcnt(14)
  v_mfma_f32_16x16x32_bf16 v[104:107], v[44:47], a[176:179], v[104:107]
  s_waitcnt lgkmcnt(13)
  v_mfma_f32_16x16x32_bf16 v[104:107], v[48:51], a[224:227], v[104:107]
  s_waitcnt lgkmcnt(12)
  v_mfma_f32_16x16x32_bf16 v[104:107], v[52:55], v[240:243], v[104:107]
  s_waitcnt lgkmcnt(15)
  v_mfma_f32_16x16x32_bf16 v[108:111], v[32:35], a[36:39], 0
  s_waitcnt lgkmcnt(15)
  v_mfma_f32_16x16x32_bf16 v[108:111], v[36:39], a[84:87], v[108:111]
  v_cvt_pk_bf16_f32 v123, v96, v100
  s_waitcnt lgkmcnt(15)
  v_mfma_f32_16x16x32_bf16 v[108:111], v[40:43], a[132:135], v[108:111]
  v_cvt_pk_bf16_f32 v127, v97, v101
  s_waitcnt lgkmcnt(14)
  v_mfma_f32_16x16x32_bf16 v[108:111], v[44:47], a[180:183], v[108:111]
  v_cvt_pk_bf16_f32 v131, v98, v102
  s_waitcnt lgkmcnt(13)
  v_mfma_f32_16x16x32_bf16 v[108:111], v[48:51], a[228:231], v[108:111]
  v_cvt_pk_bf16_f32 v135, v99, v103
  s_waitcnt lgkmcnt(12)
  v_mfma_f32_16x16x32_bf16 v[108:111], v[52:55], v[244:247], v[108:111]
  s_waitcnt lgkmcnt(11)
  v_mfma_f32_16x16x32_bf16 v[112:115], v[32:35], a[40:43], 0
  s_branch L_table
L_table_done:
  s_add_u32 s50, s22, 6291456
  s_add_u32 s43, s50, 24576
  s_lshr_b32 s43, s43, 21
  s_lshr_b32 s45, s43, 1
  s_lshr_b32 s45, s40, s45
  s_xor_b32 s43, s43, s45
  s_xor_b32 s43, s43, s39
  s_bitcmp1_b32 s45, 14
  s_cselect_b32 s43, s38, s43
  s_and_b32 s43, s43, 1
  s_mul_i32 s54, s43, 127
  s_add_u32 m0, s25, 0
  v_xor_b32 v56, s54, v10
  v_mad_u32_u24 v56, v56, s44, v16
  buffer_load_dwordx4 v56, s[4:7], s50 offen nt lds
  s_add_u32 m0, s25, 1024
  v_xor_b32 v56, s54, v11
  v_mad_u32_u24 v56, v56, s44, v17
  buffer_load_dwordx4 v56, s[4:7], s50 offen nt lds
  s_add_u32 m0, s25, 2048
  v_xor_b32 v56, s54, v12
  v_mad_u32_u24 v56, v56, s44, v18
  buffer_load_dwordx4 v56, s[4:7], s50 offen nt lds
  s_add_u32 m0, s25, 3072
  v_xor_b32 v56, s54, v13
  v_mad_u32_u24 v56, v56, s44, v19
  buffer_load_dwordx4 v56, s[4:7], s50 offen nt lds
  s_add_u32 m0, s25, 4096
  v_xor_b32 v56, s54, v14
  v_mad_u32_u24 v56, v56, s44, v20
  buffer_load_dwordx4 v56, s[4:7], s50 offen nt lds
  s_add_u32 m0, s25, 5120
  v_xor_b32 v56, s54, v15
  v_mad_u32_u24 v56, v56, s44, v21
  buffer_load_dwordx4 v56, s[4:7], s50 offen nt lds
  s_waitcnt lgkmcnt(10)
  v_mfma_f32_16x16x32_bf16 v[112:115], v[36:39], a[88:91], v[112:115]
  buffer_store_dwordx4 v[120:123], v62, s[8:11], s48 offen sc0 sc1
  s_waitcnt lgkmcnt(9)
  v_mfma_f32_16x16x32_bf16 v[112:115], v[40:43], a[136:139], v[112:115]
  buffer_store_dwordx4 v[124:127], v63, s[8:11], s48 offen sc0 sc1
  s_waitcnt lgkmcnt(8)
  v_mfma_f32_16x16x32_bf16 v[112:115], v[44:47], a[184:187], v[112:115]
  buffer_store_dwordx4 v[128:131], v64, s[8:11], s48 offen sc0 sc1
  s_waitcnt lgkmcnt(7)
  v_mfma_f32_16x16x32_bf16 v[112:115], v[48:51], a[232:235], v[112:115]
  buffer_store_dwordx4 v[132:135], v65, s[8:11], s48 offen sc0 sc1
  s_waitcnt lgkmcnt(6)
  v_mfma_f32_16x16x32_bf16 v[112:115], v[52:55], v[248:251], v[112:115]
  s_waitcnt vmcnt(10)
  s_waitcnt lgkmcnt(5)
  v_mfma_f32_16x16x32_bf16 v[116:119], v[32:35], a[44:47], 0
  ds_read_b128 v[32:35], v30 offset:6144
  s_waitcnt lgkmcnt(4)
  v_mfma_f32_16x16x32_bf16 v[116:119], v[36:39], a[92:95], v[116:119]
  v_cvt_pk_bf16_f32 v136, v104, v108
  ds_read_b128 v[36:39], v31 offset:6144
  s_waitcnt lgkmcnt(3)
  v_mfma_f32_16x16x32_bf16 v[116:119], v[40:43], a[140:143], v[116:119]
  v_cvt_pk_bf16_f32 v138, v105, v109
  ds_read_b128 v[40:43], v30 offset:6272
  s_waitcnt lgkmcnt(2)
  v_mfma_f32_16x16x32_bf16 v[116:119], v[44:47], a[188:191], v[116:119]
  v_cvt_pk_bf16_f32 v140, v106, v110
  ds_read_b128 v[44:47], v31 offset:6272
  s_waitcnt lgkmcnt(1)
  v_mfma_f32_16x16x32_bf16 v[116:119], v[48:51], a[236:239], v[116:119]
  v_cvt_pk_bf16_f32 v142, v107, v111
  ds_read_b128 v[48:51], v30 offset:6400
  s_waitcnt lgkmcnt(0)
  v_mfma_f32_16x16x32_bf16 v[116:119], v[52:55], v[252:255], v[116:119]
  ds_read_b128 v[52:55], v31 offset:6400
  s_waitcnt lgkmcnt(5)
  v_mfma_f32_16x16x32_bf16 v[72:75], v[32:35], a[0:3], 0
  s_waitcnt lgkmcnt(4)
  v_mfma_f32_16x16x32_bf16 v[72:75], v[36:39], a[48:51], v[72:75]
  s_waitcnt lgkmcnt(3)
  v_mfma_f32_16x16x32_bf16 v[72:75], v[40:43], a[96:99], v[72:75]
  s_waitcnt lgkmcnt(2)
  v_mfma_f32_16x16x32_bf16 v[72:75], v[44:47], a[144:147], v[72:75]
  s_waitcnt lgkmcnt(1)
  v_mfma_f32_16x16x32_bf16 v[72:75], v[48:51], a[192:195], v[72:75]
  s_waitcnt lgkmcnt(0)
  v_mfma_f32_16x16x32_bf16 v[72:75], v[52:55], a[240:243], v[72:75]
  v_mfma_f32_16x16x32_bf16 v[76:79], v[32:35], a[4:7], 0
  v_cvt_pk_bf16_f32 v137, v112, v116
  v_mfma_f32_16x16x32_bf16 v[76:79], v[36:39], a[52:55], v[76:79]
  v_cvt_pk_bf16_f32 v139, v113, v117
  v_mfma_f32_16x16x32_bf16 v[76:79], v[40:43], a[100:103], v[76:79]
  v_cvt_pk_bf16_f32 v141, v114, v118
  v_mfma_f32_16x16x32_bf16 v[76:79], v[44:47], a[148:151], v[76:79]
  v_cvt_pk_bf16_f32 v143, v115, v119
  v_mfma_f32_16x16x32_bf16 v[76:79], v[48:51], a[196:199], v[76:79]
  v_mfma_f32_16x16x32_bf16 v[76:79], v[52:55], a[244:247], v[76:79]
  v_mfma_f32_16x16x32_bf16 v[80:83], v[32:35], a[8:11], 0
  buffer_store_dwordx2 v[136:137], v66, s[8:11], s48 offen sc0 sc1
  v_mfma_f32_16x16x32_bf16 v[80:83], v[36:39], a[56:59], v[80:83]
  buffer_store_dwordx2 v[138:139], v67, s[8:11], s48 offen sc0 sc1
  v_mfma_f32_16x16x32_bf16 v[80:83], v[40:43], a[104:107], v[80:83]
  buffer_store_dwordx2 v[140:141], v68, s[8:11], s48 offen sc0 sc1
  v_mfma_f32_16x16x32_bf16 v[80:83], v[44:47], a[152:155], v[80:83]
  buffer_store_dwordx2 v[142:143], v69, s[8:11], s48 offen sc0 sc1
  v_mfma_f32_16x16x32_bf16 v[80:83], v[48:51], a[200:203], v[80:83]
  v_mfma_f32_16x16x32_bf16 v[80:83], v[52:55], a[248:251], v[80:83]
  v_mfma_f32_16x16x32_bf16 v[84:87], v[32:35], a[12:15], 0
  s_add_u32 s51, s21, 9437184
  s_add_u32 s43, s51, 24576
  s_lshr_b32 s43, s43, 21
  s_lshr_b32 s45, s43, 1
  s_lshr_b32 s45, s40, s45
  s_xor_b32 s43, s43, s45
  s_xor_b32 s43, s43, s39
  s_bitcmp1_b32 s45, 14
  s_cselect_b32 s43, s38, s43
  s_and_b32 s43, s43, 1
  s_mul_i32 s55, s43, 127
  s_add_u32 m0, s25, 6144
  v_xor_b32 v56, s55, v10
  v_mad_u32_u24 v56, v56, s44, v16
  buffer_load_dwordx4 v56, s[4:7], s51 offen nt lds
  v_mfma_f32_16x16x32_bf16 v[84:87], v[36:39], a[60:63], v[84:87]
  v_cvt_pk_bf16_f32 v120, v72, v76
  v_mfma_f32_16x16x32_bf16 v[84:87], v[40:43], a[108:111], v[84:87]
  v_cvt_pk_bf16_f32 v124, v73, v77
  v_mfma_f32_16x16x32_bf16 v[84:87], v[44:47], a[156:159], v[84:87]
  v_cvt_pk_bf16_f32 v128, v74, v78
  v_mfma_f32_16x16x32_bf16 v[84:87], v[48:51], a[204:207], v[84:87]
  v_cvt_pk_bf16_f32 v132, v75, v79
  v_mfma_f32_16x16x32_bf16 v[84:87], v[52:55], a[252:255], v[84:87]
  v_mfma_f32_16x16x32_bf16 v[88:91], v[32:35], a[16:19], 0
  s_add_u32 m0, s25, 7168
  v_xor_b32 v56, s55, v11
  v_mad_u32_u24 v56, v56, s44, v17
  buffer_load_dwordx4 v56, s[4:7], s51 offen nt lds
  v_mfma_f32_16x16x32_bf16 v[88:91], v[36:39], a[64:67], v[88:91]
  v_xor_b32 v57, s53, v22
  v_mad_u32_u24 v62, v57, s44, v26
  v_add_u32 v66, v62, v27
  v_mfma_f32_16x16x32_bf16 v[88:91], v[40:43], a[112:115], v[88:91]
  v_xor_b32 v57, s53, v23
  v_mad_u32_u24 v63, v57, s44, v26
  v_add_u32 v67, v63, v27
  v_mfma_f32_16x16x32_bf16 v[88:91], v[44:47], a[160:163], v[88:91]
  v_xor_b32 v57, s53, v24
  v_mad_u32_u24 v64, v57, s44, v26
  v_add_u32 v68, v64, v27
  v_mfma_f32_16x16x32_bf16 v[88:91], v[48:51], a[208:211], v[88:91]
  v_xor_b32 v57, s53, v25
  v_mad_u32_u24 v65, v57, s44, v26
  v_add_u32 v69, v65, v27
  v_mfma_f32_16x16x32_bf16 v[88:91], v[52:55], v[224:227], v[88:91]
  v_mfma_f32_16x16x32_bf16 v[92:95], v[32:35], a[20:23], 0
  s_add_u32 m0, s25, 8192
  v_xor_b32 v56, s55, v12
  v_mad_u32_u24 v56, v56, s44, v18
  buffer_load_dwordx4 v56, s[4:7], s51 offen nt lds
  v_mfma_f32_16x16x32_bf16 v[92:95], v[36:39], a[68:71], v[92:95]
  v_cvt_pk_bf16_f32 v121, v80, v84
  v_mfma_f32_16x16x32_bf16 v[92:95], v[40:43], a[116:119], v[92:95]
  v_cvt_pk_bf16_f32 v125, v81, v85
  v_mfma_f32_16x16x32_bf16 v[92:95], v[44:47], a[164:167], v[92:95]
  v_cvt_pk_bf16_f32 v129, v82, v86
  v_mfma_f32_16x16x32_bf16 v[92:95], v[48:51], a[212:215], v[92:95]
  v_cvt_pk_bf16_f32 v133, v83, v87
  v_mfma_f32_16x16x32_bf16 v[92:95], v[52:55], v[228:231], v[92:95]
  v_mfma_f32_16x16x32_bf16 v[96:99], v[32:35], a[24:27], 0
  s_add_u32 m0, s25, 9216
  v_xor_b32 v56, s55, v13
  v_mad_u32_u24 v56, v56, s44, v19
  buffer_load_dwordx4 v56, s[4:7], s51 offen nt lds
  v_mfma_f32_16x16x32_bf16 v[96:99], v[36:39], a[72:75], v[96:99]
  v_mfma_f32_16x16x32_bf16 v[96:99], v[40:43], a[120:123], v[96:99]
  v_mfma_f32_16x16x32_bf16 v[96:99], v[44:47], a[168:171], v[96:99]
  v_mfma_f32_16x16x32_bf16 v[96:99], v[48:51], a[216:219], v[96:99]
  v_mfma_f32_16x16x32_bf16 v[96:99], v[52:55], v[232:235], v[96:99]
  v_mfma_f32_16x16x32_bf16 v[100:103], v[32:35], a[28:31], 0
  s_add_u32 m0, s25, 10240
  v_xor_b32 v56, s55, v14
  v_mad_u32_u24 v56, v56, s44, v20
  buffer_load_dwordx4 v56, s[4:7], s51 offen nt lds
  v_mfma_f32_16x16x32_bf16 v[100:103], v[36:39], a[76:79], v[100:103]
  v_cvt_pk_bf16_f32 v122, v88, v92
  v_mfma_f32_16x16x32_bf16 v[100:103], v[40:43], a[124:127], v[100:103]
  v_cvt_pk_bf16_f32 v126, v89, v93
  v_mfma_f32_16x16x32_bf16 v[100:103], v[44:47], a[172:175], v[100:103]
  v_cvt_pk_bf16_f32 v130, v90, v94
  v_mfma_f32_16x16x32_bf16 v[100:103], v[48:51], a[220:223], v[100:103]
  v_cvt_pk_bf16_f32 v134, v91, v95
  v_mfma_f32_16x16x32_bf16 v[100:103], v[52:55], v[236:239], v[100:103]
  v_mfma_f32_16x16x32_bf16 v[104:107], v[32:35], a[32:35], 0
  s_add_u32 m0, s25, 11264
  v_xor_b32 v56, s55, v15
  v_mad_u32_u24 v56, v56, s44, v21
  buffer_load_dwordx4 v56, s[4:7], s51 offen nt lds
  v_mfma_f32_16x16x32_bf16 v[104:107], v[36:39], a[80:83], v[104:107]
  v_mfma_f32_16x16x32_bf16 v[104:107], v[40:43], a[128:131], v[104:107]
  v_mfma_f32_16x16x32_bf16 v[104:107], v[44:47], a[176:179], v[104:107]
  v_mfma_f32_16x16x32_bf16 v[104:107], v[48:51], a[224:227], v[104:107]
  v_mfma_f32_16x16x32_bf16 v[104:107], v[52:55], v[240:243], v[104:107]
  v_mfma_f32_16x16x32_bf16 v[108:111], v[32:35], a[36:39], 0
  v_mfma_f32_16x16x32_bf16 v[108:111], v[36:39], a[84:87], v[108:111]
  v_cvt_pk_bf16_f32 v123, v96, v100
  v_mfma_f32_16x16x32_bf16 v[108:111], v[40:43], a[132:135], v[108:111]
  v_cvt_pk_bf16_f32 v127, v97, v101
  v_mfma_f32_16x16x32_bf16 v[108:111], v[44:47], a[180:183], v[108:111]
  v_cvt_pk_bf16_f32 v131, v98, v102
  v_mfma_f32_16x16x32_bf16 v[108:111], v[48:51], a[228:231], v[108:111]
  v_cvt_pk_bf16_f32 v135, v99, v103
  v_mfma_f32_16x16x32_bf16 v[108:111], v[52:55], v[244:247], v[108:111]
  v_mfma_f32_16x16x32_bf16 v[112:115], v[32:35], a[40:43], 0
  v_mfma_f32_16x16x32_bf16 v[112:115], v[36:39], a[88:91], v[112:115]
  buffer_store_dwordx4 v[120:123], v62, s[8:11], s49 offen sc0 sc1
  v_mfma_f32_16x16x32_bf16 v[112:115], v[40:43], a[136:139], v[112:115]
  buffer_store_dwordx4 v[124:127], v63, s[8:11], s49 offen sc0 sc1
  v_mfma_f32_16x16x32_bf16 v[112:115], v[44:47], a[184:187], v[112:115]
  buffer_store_dwordx4 v[128:131], v64, s[8:11], s49 offen sc0 sc1
  v_mfma_f32_16x16x32_bf16 v[112:115], v[48:51], a[232:235], v[112:115]
  buffer_store_dwordx4 v[132:135], v65, s[8:11], s49 offen sc0 sc1
  v_mfma_f32_16x16x32_bf16 v[112:115], v[52:55], v[248:251], v[112:115]
  s_waitcnt vmcnt(18)
  v_mfma_f32_16x16x32_bf16 v[116:119], v[32:35], a[44:47], 0
  ds_read_b128 v[32:35], v30 offset:0
  v_mfma_f32_16x16x32_bf16 v[116:119], v[36:39], a[92:95], v[116:119]
  v_cvt_pk_bf16_f32 v136, v104, v108
  ds_read_b128 v[36:39], v31 offset:0
  v_mfma_f32_16x16x32_bf16 v[116:119], v[40:43], a[140:143], v[116:119]
  v_cvt_pk_bf16_f32 v138, v105, v109
  ds_read_b128 v[40:43], v30 offset:128
  v_mfma_f32_16x16x32_bf16 v[116:119], v[44:47], a[188:191], v[116:119]
  v_cvt_pk_bf16_f32 v140, v106, v110
  ds_read_b128 v[44:47], v31 offset:128
  v_mfma_f32_16x16x32_bf16 v[116:119], v[48:51], a[236:239], v[116:119]
  v_cvt_pk_bf16_f32 v142, v107, v111
  ds_read_b128 v[48:51], v30 offset:256
  v_mfma_f32_16x16x32_bf16 v[116:119], v[52:55], v[252:255], v[116:119]
  ds_read_b128 v[52:55], v31 offset:256
  s_waitcnt lgkmcnt(5)
  v_mfma_f32_16x16x32_bf16 v[72:75], v[32:35], a[0:3], 0
  s_waitcnt lgkmcnt(4)
  v_mfma_f32_16x16x32_bf16 v[72:75], v[36:39], a[48:51], v[72:75]
  s_waitcnt lgkmcnt(3)
  v_mfma_f32_16x16x32_bf16 v[72:75], v[40:43], a[96:99], v[72:75]
  s_waitcnt lgkmcnt(2)
  v_mfma_f32_16x16x32_bf16 v[72:75], v[44:47], a[144:147], v[72:75]
  s_waitcnt lgkmcnt(1)
  v_mfma_f32_16x16x32_bf16 v[72:75], v[48:51], a[192:195], v[72:75]
  s_waitcnt lgkmcnt(0)
  v_mfma_f32_16x16x32_bf16 v[72:75], v[52:55], a[240:243], v[72:75]
  v_mfma_f32_16x16x32_bf16 v[76:79], v[32:35], a[4:7], 0
  v_cvt_pk_bf16_f32 v137, v112, v116
  v_mfma_f32_16x16x32_bf16 v[76:79], v[36:39], a[52:55], v[76:79]
  v_cvt_pk_bf16_f32 v139, v113, v117
  v_mfma_f32_16x16x32_bf16 v[76:79], v[40:43], a[100:103], v[76:79]
  v_cvt_pk_bf16_f32 v141, v114, v118
  v_mfma_f32_16x16x32_bf16 v[76:79], v[44:47], a[148:151], v[76:79]
  v_cvt_pk_bf16_f32 v143, v115, v119
  v_mfma_f32_16x16x32_bf16 v[76:79], v[48:51], a[196:199], v[76:79]
  v_mfma_f32_16x16x32_bf16 v[76:79], v[52:55], a[244:247], v[76:79]
  v_mfma_f32_16x16x32_bf16 v[80:83], v[32:35], a[8:11], 0
  buffer_store_dwordx2 v[136:137], v66, s[8:11], s49 offen sc0 sc1
  v_mfma_f32_16x16x32_bf16 v[80:83], v[36:39], a[56:59], v[80:83]
  buffer_store_dwordx2 v[138:139], v67, s[8:11], s49 offen sc0 sc1
  v_mfma_f32_16x16x32_bf16 v[80:83], v[40:43], a[104:107], v[80:83]
  buffer_store_dwordx2 v[140:141], v68, s[8:11], s49 offen sc0 sc1
  v_mfma_f32_16x16x32_bf16 v[80:83], v[44:47], a[152:155], v[80:83]
  buffer_store_dwordx2 v[142:143], v69, s[8:11], s49 offen sc0 sc1
  v_mfma_f32_16x16x32_bf16 v[80:83], v[48:51], a[200:203], v[80:83]
  v_mfma_f32_16x16x32_bf16 v[80:83], v[52:55], a[248:251], v[80:83]
  v_mfma_f32_16x16x32_bf16 v[84:87], v[32:35], a[12:15], 0
  s_add_u32 s48, s22, 12582912
  s_add_u32 s43, s48, 24576
  s_lshr_b32 s43, s43, 21
  s_lshr_b32 s45, s43, 1
  s_lshr_b32 s45, s40, s45
  s_xor_b32 s43, s43, s45
  s_xor_b32 s43, s43, s39
  s_bitcmp1_b32 s45, 14
  s_cselect_b32 s43, s38, s43
  s_and_b32 s43, s43, 1
  s_mul_i32 s52, s43, 127
  s_add_u32 m0, s25, 0
  v_xor_b32 v56, s52, v10
  v_mad_u32_u24 v56, v56, s44, v16
  buffer_load_dwordx4 v56, s[4:7], s48 offen nt lds
  v_mfma_f32_16x16x32_bf16 v[84:87], v[36:39], a[60:63], v[84:87]
  v_cvt_pk_bf16_f32 v120, v72, v76
  v_mfma_f32_16x16x32_bf16 v[84:87], v[40:43], a[108:111], v[84:87]
  v_cvt_pk_bf16_f32 v124, v73, v77
  v_mfma_f32_16x16x32_bf16 v[84:87], v[44:47], a[156:159], v[84:87]
  v_cvt_pk_bf16_f32 v128, v74, v78
  v_mfma_f32_16x16x32_bf16 v[84:87], v[48:51], a[204:207], v[84:87]
  v_cvt_pk_bf16_f32 v132, v75, v79
  v_mfma_f32_16x16x32_bf16 v[84:87], v[52:55], a[252:255], v[84:87]
  v_mfma_f32_16x16x32_bf16 v[88:91], v[32:35], a[16:19], 0
  s_add_u32 m0, s25, 1024
  v_xor_b32 v56, s52, v11
  v_mad_u32_u24 v56, v56, s44, v17
  buffer_load_dwordx4 v56, s[4:7], s48 offen nt lds
  v_mfma_f32_16x16x32_bf16 v[88:91], v[36:39], a[64:67], v[88:91]
  v_xor_b32 v57, s54, v22
  v_mad_u32_u24 v62, v57, s44, v26
  v_add_u32 v66, v62, v27
  v_mfma_f32_16x16x32_bf16 v[88:91], v[40:43], a[112:115], v[88:91]
  v_xor_b32 v57, s54, v23
  v_mad_u32_u24 v63, v57, s44, v26
  v_add_u32 v67, v63, v27
  v_mfma_f32_16x16x32_bf16 v[88:91], v[44:47], a[160:163], v[88:91]
  v_xor_b32 v57, s54, v24
  v_mad_u32_u24 v64, v57, s44, v26
  v_add_u32 v68, v64, v27
  v_mfma_f32_16x16x32_bf16 v[88:91], v[48:51], a[208:211], v[88:91]
  v_xor_b32 v57, s54, v25
  v_mad_u32_u24 v65, v57, s44, v26
  v_add_u32 v69, v65, v27
  v_mfma_f32_16x16x32_bf16 v[88:91], v[52:55], v[224:227], v[88:91]
  v_mfma_f32_16x16x32_bf16 v[92:95], v[32:35], a[20:23], 0
  s_add_u32 m0, s25, 2048
  v_xor_b32 v56, s52, v12
  v_mad_u32_u24 v56, v56, s44, v18
  buffer_load_dwordx4 v56, s[4:7], s48 offen nt lds
  v_mfma_f32_16x16x32_bf16 v[92:95], v[36:39], a[68:71], v[92:95]
  v_cvt_pk_bf16_f32 v121, v80, v84
  v_mfma_f32_16x16x32_bf16 v[92:95], v[40:43], a[116:119], v[92:95]
  v_cvt_pk_bf16_f32 v125, v81, v85
  v_mfma_f32_16x16x32_bf16 v[92:95], v[44:47], a[164:167], v[92:95]
  v_cvt_pk_bf16_f32 v129, v82, v86
  v_mfma_f32_16x16x32_bf16 v[92:95], v[48:51], a[212:215], v[92:95]
  v_cvt_pk_bf16_f32 v133, v83, v87
  v_mfma_f32_16x16x32_bf16 v[92:95], v[52:55], v[228:231], v[92:95]
  v_mfma_f32_16x16x32_bf16 v[96:99], v[32:35], a[24:27], 0
  s_add_u32 m0, s25, 3072
  v_xor_b32 v56, s52, v13
  v_mad_u32_u24 v56, v56, s44, v19
  buffer_load_dwordx4 v56, s[4:7], s48 offen nt lds
  v_mfma_f32_16x16x32_bf16 v[96:99], v[36:39], a[72:75], v[96:99]
  v_mfma_f32_16x16x32_bf16 v[96:99], v[40:43], a[120:123], v[96:99]
  v_mfma_f32_16x16x32_bf16 v[96:99], v[44:47], a[168:171], v[96:99]
  v_mfma_f32_16x16x32_bf16 v[96:99], v[48:51], a[216:219], v[96:99]
  v_mfma_f32_16x16x32_bf16 v[96:99], v[52:55], v[232:235], v[96:99]
  v_mfma_f32_16x16x32_bf16 v[100:103], v[32:35], a[28:31], 0
  s_add_u32 m0, s25, 4096
  v_xor_b32 v56, s52, v14
  v_mad_u32_u24 v56, v56, s44, v20
  buffer_load_dwordx4 v56, s[4:7], s48 offen nt lds
  v_mfma_f32_16x16x32_bf16 v[100:103], v[36:39], a[76:79], v[100:103]
  v_cvt_pk_bf16_f32 v122, v88, v92
  v_mfma_f32_16x16x32_bf16 v[100:103], v[40:43], a[124:127], v[100:103]
  v_cvt_pk_bf16_f32 v126, v89, v93
  v_mfma_f32_16x16x32_bf16 v[100:103], v[44:47], a[172:175], v[100:103]
  v_cvt_pk_bf16_f32 v130, v90, v94
  v_mfma_f32_16x16x32_bf16 v[100:103], v[48:51], a[220:223], v[100:103]
  v_cvt_pk_bf16_f32 v134, v91, v95
  v_mfma_f32_16x16x32_bf16 v[100:103], v[52:55], v[236:239], v[100:103]
  v_mfma_f32_16x16x32_bf16 v[104:107], v[32:35], a[32:35], 0
  s_add_u32 m0, s25, 5120
  v_xor_b32 v56, s52, v15
  v_mad_u32_u24 v56, v56, s44, v21
  buffer_load_dwordx4 v56, s[4:7], s48 offen nt lds
  v_mfma_f32_16x16x32_bf16 v[104:107], v[36:39], a[80:83], v[104:107]
  v_mfma_f32_16x16x32_bf16 v[104:107], v[40:43], a[128:131], v[104:107]
  v_mfma_f32_16x16x32_bf16 v[104:107], v[44:47], a[176:179], v[104:107]
  v_mfma_f32_16x16x32_bf16 v[104:107], v[48:51], a[224:227], v[104:107]
  v_mfma_f32_16x16x32_bf16 v[104:107], v[52:55], v[240:243], v[104:107]
  v_mfma_f32_16x16x32_bf16 v[108:111], v[32:35], a[36:39], 0
  v_mfma_f32_16x16x32_bf16 v[108:111], v[36:39], a[84:87], v[108:111]
  v_cvt_pk_bf16_f32 v123, v96, v100
  v_mfma_f32_16x16x32_bf16 v[108:111], v[40:43], a[132:135], v[108:111]
  v_cvt_pk_bf16_f32 v127, v97, v101
  v_mfma_f32_16x16x32_bf16 v[108:111], v[44:47], a[180:183], v[108:111]
  v_cvt_pk_bf16_f32 v131, v98, v102
  v_mfma_f32_16x16x32_bf16 v[108:111], v[48:51], a[228:231], v[108:111]
  v_cvt_pk_bf16_f32 v135, v99, v103
  v_mfma_f32_16x16x32_bf16 v[108:111], v[52:55], v[244:247], v[108:111]
  v_mfma_f32_16x16x32_bf16 v[112:115], v[32:35], a[40:43], 0
  v_mfma_f32_16x16x32_bf16 v[112:115], v[36:39], a[88:91], v[112:115]
  buffer_store_dwordx4 v[120:123], v62, s[8:11], s50 offen sc0 sc1
  v_mfma_f32_16x16x32_bf16 v[112:115], v[40:43], a[136:139], v[112:115]
  buffer_store_dwordx4 v[124:127], v63, s[8:11], s50 offen sc0 sc1
  v_mfma_f32_16x16x32_bf16 v[112:115], v[44:47], a[184:187], v[112:115]
  buffer_store_dwordx4 v[128:131], v64, s[8:11], s50 offen sc0 sc1
  v_mfma_f32_16x16x32_bf16 v[112:115], v[48:51], a[232:235], v[112:115]
  buffer_store_dwordx4 v[132:135], v65, s[8:11], s50 offen sc0 sc1
  v_mfma_f32_16x16x32_bf16 v[112:115], v[52:55], v[248:251], v[112:115]
  s_waitcnt vmcnt(18)
  v_mfma_f32_16x16x32_bf16 v[116:119], v[32:35], a[44:47], 0
  ds_read_b128 v[32:35], v30 offset:6144
  v_mfma_f32_16x16x32_bf16 v[116:119], v[36:39], a[92:95], v[116:119]
  v_cvt_pk_bf16_f32 v136, v104, v108
  ds_read_b128 v[36:39], v31 offset:6144
  v_mfma_f32_16x16x32_bf16 v[116:119], v[40:43], a[140:143], v[116:119]
  v_cvt_pk_bf16_f32 v138, v105, v109
  ds_read_b128 v[40:43], v30 offset:6272
  v_mfma_f32_16x16x32_bf16 v[116:119], v[44:47], a[188:191], v[116:119]
  v_cvt_pk_bf16_f32 v140, v106, v110
  ds_read_b128 v[44:47], v31 offset:6272
  v_mfma_f32_16x16x32_bf16 v[116:119], v[48:51], a[236:239], v[116:119]
  v_cvt_pk_bf16_f32 v142, v107, v111
  ds_read_b128 v[48:51], v30 offset:6400
  v_mfma_f32_16x16x32_bf16 v[116:119], v[52:55], v[252:255], v[116:119]
  ds_read_b128 v[52:55], v31 offset:6400
  s_waitcnt lgkmcnt(5)
  v_mfma_f32_16x16x32_bf16 v[72:75], v[32:35], a[0:3], 0
  s_waitcnt lgkmcnt(4)
  v_mfma_f32_16x16x32_bf16 v[72:75], v[36:39], a[48:51], v[72:75]
  s_waitcnt lgkmcnt(3)
  v_mfma_f32_16x16x32_bf16 v[72:75], v[40:43], a[96:99], v[72:75]
  s_waitcnt lgkmcnt(2)
  v_mfma_f32_16x16x32_bf16 v[72:75], v[44:47], a[144:147], v[72:75]
  s_waitcnt lgkmcnt(1)
  v_mfma_f32_16x16x32_bf16 v[72:75], v[48:51], a[192:195], v[72:75]
  s_waitcnt lgkmcnt(0)
  v_mfma_f32_16x16x32_bf16 v[72:75], v[52:55], a[240:243], v[72:75]
  v_mfma_f32_16x16x32_bf16 v[76:79], v[32:35], a[4:7], 0
  v_cvt_pk_bf16_f32 v137, v112, v116
  v_mfma_f32_16x16x32_bf16 v[76:79], v[36:39], a[52:55], v[76:79]
  v_cvt_pk_bf16_f32 v139, v113, v117
  v_mfma_f32_16x16x32_bf16 v[76:79], v[40:43], a[100:103], v[76:79]
  v_cvt_pk_bf16_f32 v141, v114, v118
  v_mfma_f32_16x16x32_bf16 v[76:79], v[44:47], a[148:151], v[76:79]
  v_cvt_pk_bf16_f32 v143, v115, v119
  v_mfma_f32_16x16x32_bf16 v[76:79], v[48:51], a[196:199], v[76:79]
  v_mfma_f32_16x16x32_bf16 v[76:79], v[52:55], a[244:247], v[76:79]
  v_mfma_f32_16x16x32_bf16 v[80:83], v[32:35], a[8:11], 0
  buffer_store_dwordx2 v[136:137], v66, s[8:11], s50 offen sc0 sc1
  v_mfma_f32_16x16x32_bf16 v[80:83], v[36:39], a[56:59], v[80:83]
  buffer_store_dwordx2 v[138:139], v67, s[8:11], s50 offen sc0 sc1
  v_mfma_f32_16x16x32_bf16 v[80:83], v[40:43], a[104:107], v[80:83]
  buffer_store_dwordx2 v[140:141], v68, s[8:11], s50 offen sc0 sc1
  v_mfma_f32_16x16x32_bf16 v[80:83], v[44:47], a[152:155], v[80:83]
  buffer_store_dwordx2 v[142:143], v69, s[8:11], s50 offen sc0 sc1
  v_mfma_f32_16x16x32_bf16 v[80:83], v[48:51], a[200:203], v[80:83]
  v_mfma_f32_16x16x32_bf16 v[80:83], v[52:55], a[248:251], v[80:83]
  v_mfma_f32_16x16x32_bf16 v[84:87], v[32:35], a[12:15], 0
  s_add_u32 s49, s21, 15728640
  s_add_u32 s43, s49, 24576
  s_lshr_b32 s43, s43, 21
  s_lshr_b32 s45, s43, 1
  s_lshr_b32 s45, s40, s45
  s_xor_b32 s43, s43, s45
  s_xor_b32 s43, s43, s39
  s_bitcmp1_b32 s45, 14
  s_cselect_b32 s43, s38, s43
  s_and_b32 s43, s43, 1
  s_mul_i32 s53, s43, 127
  s_add_u32 m0, s25, 6144
  v_xor_b32 v56, s53, v10
  v_mad_u32_u24 v56, v56, s44, v16
  buffer_load_dwordx4 v56, s[4:7], s49 offen nt lds
  v_mfma_f32_16x16x32_bf16 v[84:87], v[36:39], a[60:63], v[84:87]
  v_cvt_pk_bf16_f32 v120, v72, v76
  v_mfma_f32_16x16x32_bf16 v[84:87], v[40:43], a[108:111], v[84:87]
  v_cvt_pk_bf16_f32 v124, v73, v77
  v_mfma_f32_16x16x32_bf16 v[84:87], v[44:47], a[156:159], v[84:87]
  v_cvt_pk_bf16_f32 v128, v74, v78
  v_mfma_f32_16x16x32_bf16 v[84:87], v[48:51], a[204:207], v[84:87]
  v_cvt_pk_bf16_f32 v132, v75, v79
  v_mfma_f32_16x16x32_bf16 v[84:87], v[52:55], a[252:255], v[84:87]
  v_mfma_f32_16x16x32_bf16 v[88:91], v[32:35], a[16:19], 0
  s_add_u32 m0, s25, 7168
  v_xor_b32 v56, s53, v11
  v_mad_u32_u24 v56, v56, s44, v17
  buffer_load_dwordx4 v56, s[4:7], s49 offen nt lds
  v_mfma_f32_16x16x32_bf16 v[88:91], v[36:39], a[64:67], v[88:91]
  v_xor_b32 v57, s55, v22
  v_mad_u32_u24 v62, v57, s44, v26
  v_add_u32 v66, v62, v27
  v_mfma_f32_16x16x32_bf16 v[88:91], v[40:43], a[112:115], v[88:91]
  v_xor_b32 v57, s55, v23
  v_mad_u32_u24 v63, v57, s44, v26
  v_add_u32 v67, v63, v27
  v_mfma_f32_16x16x32_bf16 v[88:91], v[44:47], a[160:163], v[88:91]
  v_xor_b32 v57, s55, v24
  v_mad_u32_u24 v64, v57, s44, v26
  v_add_u32 v68, v64, v27
  v_mfma_f32_16x16x32_bf16 v[88:91], v[48:51], a[208:211], v[88:91]
  v_xor_b32 v57, s55, v25
  v_mad_u32_u24 v65, v57, s44, v26
  v_add_u32 v69, v65, v27
  v_mfma_f32_16x16x32_bf16 v[88:91], v[52:55], v[224:227], v[88:91]
  v_mfma_f32_16x16x32_bf16 v[92:95], v[32:35], a[20:23], 0
  s_add_u32 m0, s25, 8192
  v_xor_b32 v56, s53, v12
  v_mad_u32_u24 v56, v56, s44, v18
  buffer_load_dwordx4 v56, s[4:7], s49 offen nt lds
  v_mfma_f32_16x16x32_bf16 v[92:95], v[36:39], a[68:71], v[92:95]
  v_cvt_pk_bf16_f32 v121, v80, v84
  v_mfma_f32_16x16x32_bf16 v[92:95], v[40:43], a[116:119], v[92:95]
  v_cvt_pk_bf16_f32 v125, v81, v85
  v_mfma_f32_16x16x32_bf16 v[92:95], v[44:47], a[164:167], v[92:95]
  v_cvt_pk_bf16_f32 v129, v82, v86
  v_mfma_f32_16x16x32_bf16 v[92:95], v[48:51], a[212:215], v[92:95]
  v_cvt_pk_bf16_f32 v133, v83, v87
  v_mfma_f32_16x16x32_bf16 v[92:95], v[52:55], v[228:231], v[92:95]
  v_mfma_f32_16x16x32_bf16 v[96:99], v[32:35], a[24:27], 0
  s_add_u32 m0, s25, 9216
  v_xor_b32 v56, s53, v13
  v_mad_u32_u24 v56, v56, s44, v19
  buffer_load_dwordx4 v56, s[4:7], s49 offen nt lds
  v_mfma_f32_16x16x32_bf16 v[96:99], v[36:39], a[72:75], v[96:99]
  v_mfma_f32_16x16x32_bf16 v[96:99], v[40:43], a[120:123], v[96:99]
  v_mfma_f32_16x16x32_bf16 v[96:99], v[44:47], a[168:171], v[96:99]
  v_mfma_f32_16x16x32_bf16 v[96:99], v[48:51], a[216:219], v[96:99]
  v_mfma_f32_16x16x32_bf16 v[96:99], v[52:55], v[232:235], v[96:99]
  v_mfma_f32_16x16x32_bf16 v[100:103], v[32:35], a[28:31], 0
  s_add_u32 m0, s25, 10240
  v_xor_b32 v56, s53, v14
  v_mad_u32_u24 v56, v56, s44, v20
  buffer_load_dwordx4 v56, s[4:7], s49 offen nt lds
  v_mfma_f32_16x16x32_bf16 v[100:103], v[36:39], a[76:79], v[100:103]
  v_cvt_pk_bf16_f32 v122, v88, v92
  v_mfma_f32_16x16x32_bf16 v[100:103], v[40:43], a[124:127], v[100:103]
  v_cvt_pk_bf16_f32 v126, v89, v93
  v_mfma_f32_16x16x32_bf16 v[100:103], v[44:47], a[172:175], v[100:103]
  v_cvt_pk_bf16_f32 v130, v90, v94
  v_mfma_f32_16x16x32_bf16 v[100:103], v[48:51], a[220:223], v[100:103]
  v_cvt_pk_bf16_f32 v134, v91, v95
  v_mfma_f32_16x16x32_bf16 v[100:103], v[52:55], v[236:239], v[100:103]
  v_mfma_f32_16x16x32_bf16 v[104:107], v[32:35], a[32:35], 0
  v_mfma_f32_16x16x32_bf16 v[104:107], v[36:39], a[80:83], v[104:107]
  v_mfma_f32_16x16x32_bf16 v[104:107], v[40:43], a[128:131], v[104:107]
  v_mfma_f32_16x16x32_bf16 v[104:107], v[44:47], a[176:179], v[104:107]
  v_mfma_f32_16x16x32_bf16 v[104:107], v[48:51], a[224:227], v[104:107]
  v_mfma_f32_16x16x32_bf16 v[104:107], v[52:55], v[240:243], v[104:107]
  v_mfma_f32_16x16x32_bf16 v[108:111], v[32:35], a[36:39], 0
  v_mfma_f32_16x16x32_bf16 v[108:111], v[36:39], a[84:87], v[108:111]
  v_cvt_pk_bf16_f32 v123, v96, v100
  v_mfma_f32_16x16x32_bf16 v[108:111], v[40:43], a[132:135], v[108:111]
  v_cvt_pk_bf16_f32 v127, v97, v101
  v_mfma_f32_16x16x32_bf16 v[108:111], v[44:47], a[180:183], v[108:111]
  v_cvt_pk_bf16_f32 v131, v98, v102
  v_mfma_f32_16x16x32_bf16 v[108:111], v[48:51], a[228:231], v[108:111]
  v_cvt_pk_bf16_f32 v135, v99, v103
  v_mfma_f32_16x16x32_bf16 v[108:111], v[52:55], v[244:247], v[108:111]
  v_mfma_f32_16x16x32_bf16 v[112:115], v[32:35], a[40:43], 0
  v_mfma_f32_16x16x32_bf16 v[112:115], v[36:39], a[88:91], v[112:115]
  buffer_store_dwordx4 v[120:123], v62, s[8:11], s51 offen sc0 sc1
  v_mfma_f32_16x16x32_bf16 v[112:115], v[40:43], a[136:139], v[112:115]
  buffer_store_dwordx4 v[124:127], v63, s[8:11], s51 offen sc0 sc1
  v_mfma_f32_16x16x32_bf16 v[112:115], v[44:47], a[184:187], v[112:115]
  buffer_store_dwordx4 v[128:131], v64, s[8:11], s51 offen sc0 sc1
  v_mfma_f32_16x16x32_bf16 v[112:115], v[48:51], a[232:235], v[112:115]
  buffer_store_dwordx4 v[132:135], v65, s[8:11], s51 offen sc0 sc1
  v_mfma_f32_16x16x32_bf16 v[112:115], v[52:55], v[248:251], v[112:115]
  s_waitcnt vmcnt(17)
  v_mfma_f32_16x16x32_bf16 v[116:119], v[32:35], a[44:47], 0
  ds_read_b128 v[32:35], v30 offset:0
  v_mfma_f32_16x16x32_bf16 v[116:119], v[36:39], a[92:95], v[116:119]
  v_cvt_pk_bf16_f32 v136, v104, v108
  ds_read_b128 v[36:39], v31 offset:0
  v_mfma_f32_16x16x32_bf16 v[116:119], v[40:43], a[140:143], v[116:119]
  v_cvt_pk_bf16_f32 v138, v105, v109
  ds_read_b128 v[40:43], v30 offset:128
  v_mfma_f32_16x16x32_bf16 v[116:119], v[44:47], a[188:191], v[116:119]
  v_cvt_pk_bf16_f32 v140, v106, v110
  ds_read_b128 v[44:47], v31 offset:128
  v_mfma_f32_16x16x32_bf16 v[116:119], v[48:51], a[236:239], v[116:119]
  v_cvt_pk_bf16_f32 v142, v107, v111
  ds_read_b128 v[48:51], v30 offset:256
  v_mfma_f32_16x16x32_bf16 v[116:119], v[52:55], v[252:255], v[116:119]
  ds_read_b128 v[52:55], v31 offset:256
  s_waitcnt lgkmcnt(5)
  v_mfma_f32_16x16x32_bf16 v[72:75], v[32:35], a[0:3], 0
  s_waitcnt lgkmcnt(4)
  v_mfma_f32_16x16x32_bf16 v[72:75], v[36:39], a[48:51], v[72:75]
  s_waitcnt lgkmcnt(3)
  v_mfma_f32_16x16x32_bf16 v[72:75], v[40:43], a[96:99], v[72:75]
  s_waitcnt lgkmcnt(2)
  v_mfma_f32_16x16x32_bf16 v[72:75], v[44:47], a[144:147], v[72:75]
  s_waitcnt lgkmcnt(1)
  v_mfma_f32_16x16x32_bf16 v[72:75], v[48:51], a[192:195], v[72:75]
  s_waitcnt lgkmcnt(0)
  v_mfma_f32_16x16x32_bf16 v[72:75], v[52:55], a[240:243], v[72:75]
  v_mfma_f32_16x16x32_bf16 v[76:79], v[32:35], a[4:7], 0
  v_cvt_pk_bf16_f32 v137, v112, v116
  v_mfma_f32_16x16x32_bf16 v[76:79], v[36:39], a[52:55], v[76:79]
  v_cvt_pk_bf16_f32 v139, v113, v117
  v_mfma_f32_16x16x32_bf16 v[76:79], v[40:43], a[100:103], v[76:79]
  v_cvt_pk_bf16_f32 v141, v114, v118
  v_mfma_f32_16x16x32_bf16 v[76:79], v[44:47], a[148:151], v[76:79]
  v_cvt_pk_bf16_f32 v143, v115, v119
  v_mfma_f32_16x16x32_bf16 v[76:79], v[48:51], a[196:199], v[76:79]
  v_mfma_f32_16x16x32_bf16 v[76:79], v[52:55], a[244:247], v[76:79]
  v_mfma_f32_16x16x32_bf16 v[80:83], v[32:35], a[8:11], 0
  buffer_store_dwordx2 v[136:137], v66, s[8:11], s51 offen sc0 sc1
  v_mfma_f32_16x16x32_bf16 v[80:83], v[36:39], a[56:59], v[80:83]
  buffer_store_dwordx2 v[138:139], v67, s[8:11], s51 offen sc0 sc1
  v_mfma_f32_16x16x32_bf16 v[80:83], v[40:43], a[104:107], v[80:83]
  buffer_store_dwordx2 v[140:141], v68, s[8:11], s51 offen sc0 sc1
  v_mfma_f32_16x16x32_bf16 v[80:83], v[44:47], a[152:155], v[80:83]
  buffer_store_dwordx2 v[142:143], v69, s[8:11], s51 offen sc0 sc1
  v_mfma_f32_16x16x32_bf16 v[80:83], v[48:51], a[200:203], v[80:83]
  v_mfma_f32_16x16x32_bf16 v[80:83], v[52:55], a[248:251], v[80:83]
  v_mfma_f32_16x16x32_bf16 v[84:87], v[32:35], a[12:15], 0
  s_add_u32 m0, s25, 11264
  v_xor_b32 v56, s53, v15
  v_mad_u32_u24 v56, v56, s44, v21
  buffer_load_dwordx4 v56, s[4:7], s49 offen nt lds
  v_mfma_f32_16x16x32_bf16 v[84:87], v[36:39], a[60:63], v[84:87]
  v_cvt_pk_bf16_f32 v120, v72, v76
  v_mfma_f32_16x16x32_bf16 v[84:87], v[40:43], a[108:111], v[84:87]
  v_cvt_pk_bf16_f32 v124, v73, v77
  v_mfma_f32_16x16x32_bf16 v[84:87], v[44:47], a[156:159], v[84:87]
  v_cvt_pk_bf16_f32 v128, v74, v78
  v_mfma_f32_16x16x32_bf16 v[84:87], v[48:51], a[204:207], v[84:87]
  v_cvt_pk_bf16_f32 v132, v75, v79
  v_mfma_f32_16x16x32_bf16 v[84:87], v[52:55], a[252:255], v[84:87]
  v_mfma_f32_16x16x32_bf16 v[88:91], v[32:35], a[16:19], 0
  s_add_u32 s50, s22, 18874368
  s_add_u32 s43, s50, 24576
  s_lshr_b32 s43, s43, 21
  s_lshr_b32 s45, s43, 1
  s_lshr_b32 s45, s40, s45
  s_xor_b32 s43, s43, s45
  s_xor_b32 s43, s43, s39
  s_bitcmp1_b32 s45, 14
  s_cselect_b32 s43, s38, s43
  s_and_b32 s43, s43, 1
  s_mul_i32 s54, s43, 127
  s_add_u32 m0, s25, 0
  v_xor_b32 v56, s54, v10
  v_mad_u32_u24 v56, v56, s44, v16
  buffer_load_dwordx4 v56, s[4:7], s50 offen nt lds
  v_mfma_f32_16x16x32_bf16 v[88:91], v[36:39], a[64:67], v[88:91]
  v_xor_b32 v57, s52, v22
  v_mad_u32_u24 v62, v57, s44, v26
  v_add_u32 v66, v62, v27
  v_mfma_f32_16x16x32_bf16 v[88:91], v[40:43], a[112:115], v[88:91]
  v_xor_b32 v57, s52, v23
  v_mad_u32_u24 v63, v57, s44, v26
  v_add_u32 v67, v63, v27
  v_mfma_f32_16x16x32_bf16 v[88:91], v[44:47], a[160:163], v[88:91]
  v_xor_b32 v57, s52, v24
  v_mad_u32_u24 v64, v57, s44, v26
  v_add_u32 v68, v64, v27
  v_mfma_f32_16x16x32_bf16 v[88:91], v[48:51], a[208:211], v[88:91]
  v_xor_b32 v57, s52, v25
  v_mad_u32_u24 v65, v57, s44, v26
  v_add_u32 v69, v65, v27
  v_mfma_f32_16x16x32_bf16 v[88:91], v[52:55], v[224:227], v[88:91]
  v_mfma_f32_16x16x32_bf16 v[92:95], v[32:35], a[20:23], 0
  s_add_u32 m0, s25, 1024
  v_xor_b32 v56, s54, v11
  v_mad_u32_u24 v56, v56, s44, v17
  buffer_load_dwordx4 v56, s[4:7], s50 offen nt lds
  v_mfma_f32_16x16x32_bf16 v[92:95], v[36:39], a[68:71], v[92:95]
  v_cvt_pk_bf16_f32 v121, v80, v84
  v_mfma_f32_16x16x32_bf16 v[92:95], v[40:43], a[116:119], v[92:95]
  v_cvt_pk_bf16_f32 v125, v81, v85
  v_mfma_f32_16x16x32_bf16 v[92:95], v[44:47], a[164:167], v[92:95]
  v_cvt_pk_bf16_f32 v129, v82, v86
  v_mfma_f32_16x16x32_bf16 v[92:95], v[48:51], a[212:215], v[92:95]
  v_cvt_pk_bf16_f32 v133, v83, v87
  v_mfma_f32_16x16x32_bf16 v[92:95], v[52:55], v[228:231], v[92:95]
  v_mfma_f32_16x16x32_bf16 v[96:99], v[32:35], a[24:27], 0
  s_add_u32 m0, s25, 2048
  v_xor_b32 v56, s54, v12
  v_mad_u32_u24 v56, v56, s44, v18
  buffer_load_dwordx4 v56, s[4:7], s50 offen nt lds
  v_mfma_f32_16x16x32_bf16 v[96:99], v[36:39], a[72:75], v[96:99]
  v_mfma_f32_16x16x32_bf16 v[96:99], v[40:43], a[120:123], v[96:99]
  v_mfma_f32_16x16x32_bf16 v[96:99], v[44:47], a[168:171], v[96:99]
  v_mfma_f32_16x16x32_bf16 v[96:99], v[48:51], a[216:219], v[96:99]
  v_mfma_f32_16x16x32_bf16 v[96:99], v[52:55], v[232:235], v[96:99]
  v_mfma_f32_16x16x32_bf16 v[100:103], v[32:35], a[28:31], 0
  s_add_u32 m0, s25, 3072
  v_xor_b32 v56, s54, v13
  v_mad_u32_u24 v56, v56, s44, v19
  buffer_load_dwordx4 v56, s[4:7], s50 offen nt lds
  v_mfma_f32_16x16x32_bf16 v[100:103], v[36:39], a[76:79], v[100:103]
  v_cvt_pk_bf16_f32 v122, v88, v92
  v_mfma_f32_16x16x32_bf16 v[100:103], v[40:43], a[124:127], v[100:103]
  v_cvt_pk_bf16_f32 v126, v89, v93
  v_mfma_f32_16x16x32_bf16 v[100:103], v[44:47], a[172:175], v[100:103]
  v_cvt_pk_bf16_f32 v130, v90, v94
  v_mfma_f32_16x16x32_bf16 v[100:103], v[48:51], a[220:223], v[100:103]
  v_cvt_pk_bf16_f32 v134, v91, v95
  v_mfma_f32_16x16x32_bf16 v[100:103], v[52:55], v[236:239], v[100:103]
  v_mfma_f32_16x16x32_bf16 v[104:107], v[32:35], a[32:35], 0
  v_mfma_f32_16x16x32_bf16 v[104:107], v[36:39], a[80:83], v[104:107]
  v_mfma_f32_16x16x32_bf16 v[104:107], v[40:43], a[128:131], v[104:107]
  v_mfma_f32_16x16x32_bf16 v[104:107], v[44:47], a[176:179], v[104:107]
  v_mfma_f32_16x16x32_bf16 v[104:107], v[48:51], a[224:227], v[104:107]
  v_mfma_f32_16x16x32_bf16 v[104:107], v[52:55], v[240:243], v[104:107]
  v_mfma_f32_16x16x32_bf16 v[108:111], v[32:35], a[36:39], 0
  v_mfma_f32_16x16x32_bf16 v[108:111], v[36:39], a[84:87], v[108:111]
  v_cvt_pk_bf16_f32 v123, v96, v100
  v_mfma_f32_16x16x32_bf16 v[108:111], v[40:43], a[132:135], v[108:111]
  v_cvt_pk_bf16_f32 v127, v97, v101
  v_mfma_f32_16x16x32_bf16 v[108:111], v[44:47], a[180:183], v[108:111]
  v_cvt_pk_bf16_f32 v131, v98, v102
  v_mfma_f32_16x16x32_bf16 v[108:111], v[48:51], a[228:231], v[108:111]
  v_cvt_pk_bf16_f32 v135, v99, v103
  v_mfma_f32_16x16x32_bf16 v[108:111], v[52:55], v[244:247], v[108:111]
  v_mfma_f32_16x16x32_bf16 v[112:115], v[32:35], a[40:43], 0
  v_mfma_f32_16x16x32_bf16 v[112:115], v[36:39], a[88:91], v[112:115]
  buffer_store_dwordx4 v[120:123], v62, s[8:11], s48 offen sc0 sc1
  v_mfma_f32_16x16x32_bf16 v[112:115], v[40:43], a[136:139], v[112:115]
  buffer_store_dwordx4 v[124:127], v63, s[8:11], s48 offen sc0 sc1
  v_mfma_f32_16x16x32_bf16 v[112:115], v[44:47], a[184:187], v[112:115]
  buffer_store_dwordx4 v[128:131], v64, s[8:11], s48 offen sc0 sc1
  v_mfma_f32_16x16x32_bf16 v[112:115], v[48:51], a[232:235], v[112:115]
  buffer_store_dwordx4 v[132:135], v65, s[8:11], s48 offen sc0 sc1
  v_mfma_f32_16x16x32_bf16 v[112:115], v[52:55], v[248:251], v[112:115]
  s_waitcnt vmcnt(8)
  v_mfma_f32_16x16x32_bf16 v[116:119], v[32:35], a[44:47], 0
  ds_read_b128 v[32:35], v30 offset:6144
  v_mfma_f32_16x16x32_bf16 v[116:119], v[36:39], a[92:95], v[116:119]
  v_cvt_pk_bf16_f32 v136, v104, v108
  ds_read_b128 v[36:39], v31 offset:6144
  v_mfma_f32_16x16x32_bf16 v[116:119], v[40:43], a[140:143], v[116:119]
  v_cvt_pk_bf16_f32 v138, v105, v109
  ds_read_b128 v[40:43], v30 offset:6272
  v_mfma_f32_16x16x32_bf16 v[116:119], v[44:47], a[188:191], v[116:119]
  v_cvt_pk_bf16_f32 v140, v106, v110
  ds_read_b128 v[44:47], v31 offset:6272
  v_mfma_f32_16x16x32_bf16 v[116:119], v[48:51], a[236:239], v[116:119]
  v_cvt_pk_bf16_f32 v142, v107, v111
  ds_read_b128 v[48:51], v30 offset:6400
  v_mfma_f32_16x16x32_bf16 v[116:119], v[52:55], v[252:255], v[116:119]
  ds_read_b128 v[52:55], v31 offset:6400
  s_waitcnt lgkmcnt(5)
  v_mfma_f32_16x16x32_bf16 v[72:75], v[32:35], a[0:3], 0
  s_waitcnt lgkmcnt(4)
  v_mfma_f32_16x16x32_bf16 v[72:75], v[36:39], a[48:51], v[72:75]
  s_waitcnt lgkmcnt(3)
  v_mfma_f32_16x16x32_bf16 v[72:75], v[40:43], a[96:99], v[72:75]
  s_waitcnt lgkmcnt(2)
  v_mfma_f32_16x16x32_bf16 v[72:75], v[44:47], a[144:147], v[72:75]
  s_waitcnt lgkmcnt(1)
  v_mfma_f32_16x16x32_bf16 v[72:75], v[48:51], a[192:195], v[72:75]
  s_waitcnt lgkmcnt(0)
  v_mfma_f32_16x16x32_bf16 v[72:75], v[52:55], a[240:243], v[72:75]
  v_mfma_f32_16x16x32_bf16 v[76:79], v[32:35], a[4:7], 0
  v_cvt_pk_bf16_f32 v137, v112, v116
  v_mfma_f32_16x16x32_bf16 v[76:79], v[36:39], a[52:55], v[76:79]
  v_cvt_pk_bf16_f32 v139, v113, v117
  v_mfma_f32_16x16x32_bf16 v[76:79], v[40:43], a[100:103], v[76:79]
  v_cvt_pk_bf16_f32 v141, v114, v118
  v_mfma_f32_16x16x32_bf16 v[76:79], v[44:47], a[148:151], v[76:79]
  v_cvt_pk_bf16_f32 v143, v115, v119
  v_mfma_f32_16x16x32_bf16 v[76:79], v[48:51], a[196:199], v[76:79]
  v_mfma_f32_16x16x32_bf16 v[76:79], v[52:55], a[244:247], v[76:79]
  v_mfma_f32_16x16x32_bf16 v[80:83], v[32:35], a[8:11], 0
  buffer_store_dwordx2 v[136:137], v66, s[8:11], s48 offen sc0 sc1
  v_mfma_f32_16x16x32_bf16 v[80:83], v[36:39], a[56:59], v[80:83]
  buffer_store_dwordx2 v[138:139], v67, s[8:11], s48 offen sc0 sc1
  v_mfma_f32_16x16x32_bf16 v[80:83], v[40:43], a[104:107], v[80:83]
  buffer_store_dwordx2 v[140:141], v68, s[8:11], s48 offen sc0 sc1
  v_mfma_f32_16x16x32_bf16 v[80:83], v[44:47], a[152:155], v[80:83]
  buffer_store_dwordx2 v[142:143], v69, s[8:11], s48 offen sc0 sc1
  v_mfma_f32_16x16x32_bf16 v[80:83], v[48:51], a[200:203], v[80:83]
  v_mfma_f32_16x16x32_bf16 v[80:83], v[52:55], a[248:251], v[80:83]
  v_mfma_f32_16x16x32_bf16 v[84:87], v[32:35], a[12:15], 0
  s_add_u32 m0, s25, 4096
  v_xor_b32 v56, s54, v14
  v_mad_u32_u24 v56, v56, s44, v20
  buffer_load_dwordx4 v56, s[4:7], s50 offen nt lds
  v_mfma_f32_16x16x32_bf16 v[84:87], v[36:39], a[60:63], v[84:87]
  v_cvt_pk_bf16_f32 v120, v72, v76
  v_mfma_f32_16x16x32_bf16 v[84:87], v[40:43], a[108:111], v[84:87]
  v_cvt_pk_bf16_f32 v124, v73, v77
  v_mfma_f32_16x16x32_bf16 v[84:87], v[44:47], a[156:159], v[84:87]
  v_cvt_pk_bf16_f32 v128, v74, v78
  v_mfma_f32_16x16x32_bf16 v[84:87], v[48:51], a[204:207], v[84:87]
  v_cvt_pk_bf16_f32 v132, v75, v79
  v_mfma_f32_16x16x32_bf16 v[84:87], v[52:55], a[252:255], v[84:87]
  v_mfma_f32_16x16x32_bf16 v[88:91], v[32:35], a[16:19], 0
  s_add_u32 m0, s25, 5120
  v_xor_b32 v56, s54, v15
  v_mad_u32_u24 v56, v56, s44, v21
  buffer_load_dwordx4 v56, s[4:7], s50 offen nt lds
  v_mfma_f32_16x16x32_bf16 v[88:91], v[36:39], a[64:67], v[88:91]
  v_xor_b32 v57, s53, v22
  v_mad_u32_u24 v62, v57, s44, v26
  v_add_u32 v66, v62, v27
  v_mfma_f32_16x16x32_bf16 v[88:91], v[40:43], a[112:115], v[88:91]
  v_xor_b32 v57, s53, v23
  v_mad_u32_u24 v63, v57, s44, v26
  v_add_u32 v67, v63, v27
  v_mfma_f32_16x16x32_bf16 v[88:91], v[44:47], a[160:163], v[88:91]
  v_xor_b32 v57, s53, v24
  v_mad_u32_u24 v64, v57, s44, v26
  v_add_u32 v68, v64, v27
  v_mfma_f32_16x16x32_bf16 v[88:91], v[48:51], a[208:211], v[88:91]
  v_xor_b32 v57, s53, v25
  v_mad_u32_u24 v65, v57, s44, v26
  v_add_u32 v69, v65, v27
  v_mfma_f32_16x16x32_bf16 v[88:91], v[52:55], v[224:227], v[88:91]
  v_mfma_f32_16x16x32_bf16 v[92:95], v[32:35], a[20:23], 0
  s_add_u32 s51, s21, 22020096
  s_add_u32 s43, s51, 24576
  s_lshr_b32 s43, s43, 21
  s_lshr_b32 s45, s43, 1
  s_lshr_b32 s45, s40, s45
  s_xor_b32 s43, s43, s45
  s_xor_b32 s43, s43, s39
  s_bitcmp1_b32 s45, 14
  s_cselect_b32 s43, s38, s43
  s_and_b32 s43, s43, 1
  s_mul_i32 s55, s43, 127
  s_add_u32 m0, s25, 6144
  v_xor_b32 v56, s55, v10
  v_mad_u32_u24 v56, v56, s44, v16
  buffer_load_dwordx4 v56, s[4:7], s51 offen nt lds
  v_mfma_f32_16x16x32_bf16 v[92:95], v[36:39], a[68:71], v[92:95]
  v_cvt_pk_bf16_f32 v121, v80, v84
  v_mfma_f32_16x16x32_bf16 v[92:95], v[40:43], a[116:119], v[92:95]
  v_cvt_pk_bf16_f32 v125, v81, v85
  v_mfma_f32_16x16x32_bf16 v[92:95], v[44:47], a[164:167], v[92:95]
  v_cvt_pk_bf16_f32 v129, v82, v86
  v_mfma_f32_16x16x32_bf16 v[92:95], v[48:51], a[212:215], v[92:95]
  v_cvt_pk_bf16_f32 v133, v83, v87
  v_mfma_f32_16x16x32_bf16 v[92:95], v[52:55], v[228:231], v[92:95]
  v_mfma_f32_16x16x32_bf16 v[96:99], v[32:35], a[24:27], 0
  s_add_u32 m0, s25, 7168
  v_xor_b32 v56, s55, v11
  v_mad_u32_u24 v56, v56, s44, v17
  buffer_load_dwordx4 v56, s[4:7], s51 offen nt lds
  v_mfma_f32_16x16x32_bf16 v[96:99], v[36:39], a[72:75], v[96:99]
  v_mfma_f32_16x16x32_bf16 v[96:99], v[40:43], a[120:123], v[96:99]
  v_mfma_f32_16x16x32_bf16 v[96:99], v[44:47], a[168:171], v[96:99]
  v_mfma_f32_16x16x32_bf16 v[96:99], v[48:51], a[216:219], v[96:99]
  v_mfma_f32_16x16x32_bf16 v[96:99], v[52:55], v[232:235], v[96:99]
  v_mfma_f32_16x16x32_bf16 v[100:103], v[32:35], a[28:31], 0
  s_add_u32 m0, s25, 8192
  v_xor_b32 v56, s55, v12
  v_mad_u32_u24 v56, v56, s44, v18
  buffer_load_dwordx4 v56, s[4:7], s51 offen nt lds
  v_mfma_f32_16x16x32_bf16 v[100:103], v[36:39], a[76:79], v[100:103]
  v_cvt_pk_bf16_f32 v122, v88, v92
  v_mfma_f32_16x16x32_bf16 v[100:103], v[40:43], a[124:127], v[100:103]
  v_cvt_pk_bf16_f32 v126, v89, v93
  v_mfma_f32_16x16x32_bf16 v[100:103], v[44:47], a[172:175], v[100:103]
  v_cvt_pk_bf16_f32 v130, v90, v94
  v_mfma_f32_16x16x32_bf16 v[100:103], v[48:51], a[220:223], v[100:103]
  v_cvt_pk_bf16_f32 v134, v91, v95
  v_mfma_f32_16x16x32_bf16 v[100:103], v[52:55], v[236:239], v[100:103]
  v_mfma_f32_16x16x32_bf16 v[104:107], v[32:35], a[32:35], 0
  v_mfma_f32_16x16x32_bf16 v[104:107], v[36:39], a[80:83], v[104:107]
  v_mfma_f32_16x16x32_bf16 v[104:107], v[40:43], a[128:131], v[104:107]
  v_mfma_f32_16x16x32_bf16 v[104:107], v[44:47], a[176:179], v[104:107]
  v_mfma_f32_16x16x32_bf16 v[104:107], v[48:51], a[224:227], v[104:107]
  v_mfma_f32_16x16x32_bf16 v[104:107], v[52:55], v[240:243], v[104:107]
  v_mfma_f32_16x16x32_bf16 v[108:111], v[32:35], a[36:39], 0
  v_mfma_f32_16x16x32_bf16 v[108:111], v[36:39], a[84:87], v[108:111]
  v_cvt_pk_bf16_f32 v123, v96, v100
  v_mfma_f32_16x16x32_bf16 v[108:111], v[40:43], a[132:135], v[108:111]
  v_cvt_pk_bf16_f32 v127, v97, v101
  v_mfma_f32_16x16x32_bf16 v[108:111], v[44:47], a[180:183], v[108:111]
  v_cvt_pk_bf16_f32 v131, v98, v102
  v_mfma_f32_16x16x32_bf16 v[108:111], v[48:51], a[228:231], v[108:111]
  v_cvt_pk_bf16_f32 v135, v99, v103
  v_mfma_f32_16x16x32_bf16 v[108:111], v[52:55], v[244:247], v[108:111]
  v_mfma_f32_16x16x32_bf16 v[112:115], v[32:35], a[40:43], 0
  v_mfma_f32_16x16x32_bf16 v[112:115], v[36:39], a[88:91], v[112:115]
  buffer_store_dwordx4 v[120:123], v62, s[8:11], s49 offen sc0 sc1
  v_mfma_f32_16x16x32_bf16 v[112:115], v[40:43], a[136:139], v[112:115]
  buffer_store_dwordx4 v[124:127], v63, s[8:11], s49 offen sc0 sc1
  v_mfma_f32_16x16x32_bf16 v[112:115], v[44:47], a[184:187], v[112:115]
  buffer_store_dwordx4 v[128:131], v64, s[8:11], s49 offen sc0 sc1
  v_mfma_f32_16x16x32_bf16 v[112:115], v[48:51], a[232:235], v[112:115]
  buffer_store_dwordx4 v[132:135], v65, s[8:11], s49 offen sc0 sc1
  v_mfma_f32_16x16x32_bf16 v[112:115], v[52:55], v[248:251], v[112:115]
  s_waitcnt vmcnt(7)
  v_mfma_f32_16x16x32_bf16 v[116:119], v[32:35], a[44:47], 0
  ds_read_b128 v[32:35], v30 offset:0
  v_mfma_f32_16x16x32_bf16 v[116:119], v[36:39], a[92:95], v[116:119]
  v_cvt_pk_bf16_f32 v136, v104, v108
  ds_read_b128 v[36:39], v31 offset:0
  v_mfma_f32_16x16x32_bf16 v[116:119], v[40:43], a[140:143], v[116:119]
  v_cvt_pk_bf16_f32 v138, v105, v109
  ds_read_b128 v[40:43], v30 offset:128
  v_mfma_f32_16x16x32_bf16 v[116:119], v[44:47], a[188:191], v[116:119]
  v_cvt_pk_bf16_f32 v140, v106, v110
  ds_read_b128 v[44:47], v31 offset:128
  v_mfma_f32_16x16x32_bf16 v[116:119], v[48:51], a[236:239], v[116:119]
  v_cvt_pk_bf16_f32 v142, v107, v111
  ds_read_b128 v[48:51], v30 offset:256
  v_mfma_f32_16x16x32_bf16 v[116:119], v[52:55], v[252:255], v[116:119]
  ds_read_b128 v[52:55], v31 offset:256
  s_waitcnt lgkmcnt(5)
  v_mfma_f32_16x16x32_bf16 v[72:75], v[32:35], a[0:3], 0
  s_waitcnt lgkmcnt(4)
  v_mfma_f32_16x16x32_bf16 v[72:75], v[36:39], a[48:51], v[72:75]
  s_waitcnt lgkmcnt(3)
  v_mfma_f32_16x16x32_bf16 v[72:75], v[40:43], a[96:99], v[72:75]
  s_waitcnt lgkmcnt(2)
  v_mfma_f32_16x16x32_bf16 v[72:75], v[44:47], a[144:147], v[72:75]
  s_waitcnt lgkmcnt(1)
  v_mfma_f32_16x16x32_bf16 v[72:75], v[48:51], a[192:195], v[72:75]
  s_waitcnt lgkmcnt(0)
  v_mfma_f32_16x16x32_bf16 v[72:75], v[52:55], a[240:243], v[72:75]
  v_mfma_f32_16x16x32_bf16 v[76:79], v[32:35], a[4:7], 0
  v_cvt_pk_bf16_f32 v137, v112, v116
  v_mfma_f32_16x16x32_bf16 v[76:79], v[36:39], a[52:55], v[76:79]
  v_cvt_pk_bf16_f32 v139, v113, v117
  v_mfma_f32_16x16x32_bf16 v[76:79], v[40:43], a[100:103], v[76:79]
  v_cvt_pk_bf16_f32 v141, v114, v118
  v_mfma_f32_16x16x32_bf16 v[76:79], v[44:47], a[148:151], v[76:79]
  v_cvt_pk_bf16_f32 v143, v115, v119
  v_mfma_f32_16x16x32_bf16 v[76:79], v[48:51], a[196:199], v[76:79]
  v_mfma_f32_16x16x32_bf16 v[76:79], v[52:55], a[244:247], v[76:79]
  v_mfma_f32_16x16x32_bf16 v[80:83], v[32:35], a[8:11], 0
  buffer_store_dwordx2 v[136:137], v66, s[8:11], s49 offen sc0 sc1
  v_mfma_f32_16x16x32_bf16 v[80:83], v[36:39], a[56:59], v[80:83]
  buffer_store_dwordx2 v[138:139], v67, s[8:11], s49 offen sc0 sc1
  v_mfma_f32_16x16x32_bf16 v[80:83], v[40:43], a[104:107], v[80:83]
  buffer_store_dwordx2 v[140:141], v68, s[8:11], s49 offen sc0 sc1
  v_mfma_f32_16x16x32_bf16 v[80:83], v[44:47], a[152:155], v[80:83]
  buffer_store_dwordx2 v[142:143], v69, s[8:11], s49 offen sc0 sc1
  v_mfma_f32_16x16x32_bf16 v[80:83], v[48:51], a[200:203], v[80:83]
  v_mfma_f32_16x16x32_bf16 v[80:83], v[52:55], a[248:251], v[80:83]
  v_mfma_f32_16x16x32_bf16 v[84:87], v[32:35], a[12:15], 0
  s_add_u32 m0, s25, 9216
  v_xor_b32 v56, s55, v13
  v_mad_u32_u24 v56, v56, s44, v19
  buffer_load_dwordx4 v56, s[4:7], s51 offen nt lds
  v_mfma_f32_16x16x32_bf16 v[84:87], v[36:39], a[60:63], v[84:87]
  v_cvt_pk_bf16_f32 v120, v72, v76
  v_mfma_f32_16x16x32_bf16 v[84:87], v[40:43], a[108:111], v[84:87]
  v_cvt_pk_bf16_f32 v124, v73, v77
  v_mfma_f32_16x16x32_bf16 v[84:87], v[44:47], a[156:159], v[84:87]
  v_cvt_pk_bf16_f32 v128, v74, v78
  v_mfma_f32_16x16x32_bf16 v[84:87], v[48:51], a[204:207], v[84:87]
  v_cvt_pk_bf16_f32 v132, v75, v79
  v_mfma_f32_16x16x32_bf16 v[84:87], v[52:55], a[252:255], v[84:87]
  v_mfma_f32_16x16x32_bf16 v[88:91], v[32:35], a[16:19], 0
  s_add_u32 m0, s25, 10240
  v_xor_b32 v56, s55, v14
  v_mad_u32_u24 v56, v56, s44, v20
  buffer_load_dwordx4 v56, s[4:7], s51 offen nt lds
  v_mfma_f32_16x16x32_bf16 v[88:91], v[36:39], a[64:67], v[88:91]
  v_xor_b32 v57, s54, v22
  v_mad_u32_u24 v62, v57, s44, v26
  v_add_u32 v66, v62, v27
  v_mfma_f32_16x16x32_bf16 v[88:91], v[40:43], a[112:115], v[88:91]
  v_xor_b32 v57, s54, v23
  v_mad_u32_u24 v63, v57, s44, v26
  v_add_u32 v67, v63, v27
  v_mfma_f32_16x16x32_bf16 v[88:91], v[44:47], a[160:163], v[88:91]
  v_xor_b32 v57, s54, v24
  v_mad_u32_u24 v64, v57, s44, v26
  v_add_u32 v68, v64, v27
  v_mfma_f32_16x16x32_bf16 v[88:91], v[48:51], a[208:211], v[88:91]
  v_xor_b32 v57, s54, v25
  v_mad_u32_u24 v65, v57, s44, v26
  v_add_u32 v69, v65, v27
  v_mfma_f32_16x16x32_bf16 v[88:91], v[52:55], v[224:227], v[88:91]
  v_mfma_f32_16x16x32_bf16 v[92:95], v[32:35], a[20:23], 0
  s_add_u32 m0, s25, 11264
  v_xor_b32 v56, s55, v15
  v_mad_u32_u24 v56, v56, s44, v21
  buffer_load_dwordx4 v56, s[4:7], s51 offen nt lds
  v_mfma_f32_16x16x32_bf16 v[92:95], v[36:39], a[68:71], v[92:95]
  v_cvt_pk_bf16_f32 v121, v80, v84
  v_mfma_f32_16x16x32_bf16 v[92:95], v[40:43], a[116:119], v[92:95]
  v_cvt_pk_bf16_f32 v125, v81, v85
  v_mfma_f32_16x16x32_bf16 v[92:95], v[44:47], a[164:167], v[92:95]
  v_cvt_pk_bf16_f32 v129, v82, v86
  v_mfma_f32_16x16x32_bf16 v[92:95], v[48:51], a[212:215], v[92:95]
  v_cvt_pk_bf16_f32 v133, v83, v87
  v_mfma_f32_16x16x32_bf16 v[92:95], v[52:55], v[228:231], v[92:95]
  v_mfma_f32_16x16x32_bf16 v[96:99], v[32:35], a[24:27], 0
  s_add_u32 s48, s22, 25165824
  s_add_u32 s43, s48, 24576
  s_lshr_b32 s43, s43, 21
  s_lshr_b32 s45, s43, 1
  s_lshr_b32 s45, s40, s45
  s_xor_b32 s43, s43, s45
  s_xor_b32 s43, s43, s39
  s_bitcmp1_b32 s45, 14
  s_cselect_b32 s43, s38, s43
  s_and_b32 s43, s43, 1
  s_mul_i32 s52, s43, 127
  s_add_u32 m0, s25, 0
  v_xor_b32 v56, s52, v10
  v_mad_u32_u24 v56, v56, s44, v16
  buffer_load_dwordx4 v56, s[4:7], s48 offen nt lds
  v_mfma_f32_16x16x32_bf16 v[96:99], v[36:39], a[72:75], v[96:99]
  v_mfma_f32_16x16x32_bf16 v[96:99], v[40:43], a[120:123], v[96:99]
  v_mfma_f32_16x16x32_bf16 v[96:99], v[44:47], a[168:171], v[96:99]
  v_mfma_f32_16x16x32_bf16 v[96:99], v[48:51], a[216:219], v[96:99]
  v_mfma_f32_16x16x32_bf16 v[96:99], v[52:55], v[232:235], v[96:99]
  v_mfma_f32_16x16x32_bf16 v[100:103], v[32:35], a[28:31], 0
  s_add_u32 m0, s25, 1024
  v_xor_b32 v56, s52, v11
  v_mad_u32_u24 v56, v56, s44, v17
  buffer_load_dwordx4 v56, s[4:7], s48 offen nt lds
  v_mfma_f32_16x16x32_bf16 v[100:103], v[36:39], a[76:79], v[100:103]
  v_cvt_pk_bf16_f32 v122, v88, v92
  v_mfma_f32_16x16x32_bf16 v[100:103], v[40:43], a[124:127], v[100:103]
  v_cvt_pk_bf16_f32 v126, v89, v93
  v_mfma_f32_16x16x32_bf16 v[100:103], v[44:47], a[172:175], v[100:103]
  v_cvt_pk_bf16_f32 v130, v90, v94
  v_mfma_f32_16x16x32_bf16 v[100:103], v[48:51], a[220:223], v[100:103]
  v_cvt_pk_bf16_f32 v134, v91, v95
  v_mfma_f32_16x16x32_bf16 v[100:103], v[52:55], v[236:239], v[100:103]
  v_mfma_f32_16x16x32_bf16 v[104:107], v[32:35], a[32:35], 0
  v_mfma_f32_16x16x32_bf16 v[104:107], v[36:39], a[80:83], v[104:107]
  v_mfma_f32_16x16x32_bf16 v[104:107], v[40:43], a[128:131], v[104:107]
  v_mfma_f32_16x16x32_bf16 v[104:107], v[44:47], a[176:179], v[104:107]
  v_mfma_f32_16x16x32_bf16 v[104:107], v[48:51], a[224:227], v[104:107]
  v_mfma_f32_16x16x32_bf16 v[104:107], v[52:55], v[240:243], v[104:107]
  v_mfma_f32_16x16x32_bf16 v[108:111], v[32:35], a[36:39], 0
  v_mfma_f32_16x16x32_bf16 v[108:111], v[36:39], a[84:87], v[108:111]
  v_cvt_pk_bf16_f32 v123, v96, v100
  v_mfma_f32_16x16x32_bf16 v[108:111], v[40:43], a[132:135], v[108:111]
  v_cvt_pk_bf16_f32 v127, v97, v101
  v_mfma_f32_16x16x32_bf16 v[108:111], v[44:47], a[180:183], v[108:111]
  v_cvt_pk_bf16_f32 v131, v98, v102
  v_mfma_f32_16x16x32_bf16 v[108:111], v[48:51], a[228:231], v[108:111]
  v_cvt_pk_bf16_f32 v135, v99, v103
  v_mfma_f32_16x16x32_bf16 v[108:111], v[52:55], v[244:247], v[108:111]
  v_mfma_f32_16x16x32_bf16 v[112:115], v[32:35], a[40:43], 0
  v_mfma_f32_16x16x32_bf16 v[112:115], v[36:39], a[88:91], v[112:115]
  buffer_store_dwordx4 v[120:123], v62, s[8:11], s50 offen sc0 sc1
  v_mfma_f32_16x16x32_bf16 v[112:115], v[40:43], a[136:139], v[112:115]
  buffer_store_dwordx4 v[124:127], v63, s[8:11], s50 offen sc0 sc1
  v_mfma_f32_16x16x32_bf16 v[112:115], v[44:47], a[184:187], v[112:115]
  buffer_store_dwordx4 v[128:131], v64, s[8:11], s50 offen sc0 sc1
  v_mfma_f32_16x16x32_bf16 v[112:115], v[48:51], a[232:235], v[112:115]
  buffer_store_dwordx4 v[132:135], v65, s[8:11], s50 offen sc0 sc1
  v_mfma_f32_16x16x32_bf16 v[112:115], v[52:55], v[248:251], v[112:115]
  s_waitcnt vmcnt(6)
  v_mfma_f32_16x16x32_bf16 v[116:119], v[32:35], a[44:47], 0
  ds_read_b128 v[32:35], v30 offset:6144
  v_mfma_f32_16x16x32_bf16 v[116:119], v[36:39], a[92:95], v[116:119]
  v_cvt_pk_bf16_f32 v136, v104, v108
  ds_read_b128 v[36:39], v31 offset:6144
  v_mfma_f32_16x16x32_bf16 v[116:119], v[40:43], a[140:143], v[116:119]
  v_cvt_pk_bf16_f32 v138, v105, v109
  ds_read_b128 v[40:43], v30 offset:6272
  v_mfma_f32_16x16x32_bf16 v[116:119], v[44:47], a[188:191], v[116:119]
  v_cvt_pk_bf16_f32 v140, v106, v110
  ds_read_b128 v[44:47], v31 offset:6272
  v_mfma_f32_16x16x32_bf16 v[116:119], v[48:51], a[236:239], v[116:119]
  v_cvt_pk_bf16_f32 v142, v107, v111
  ds_read_b128 v[48:51], v30 offset:6400
  v_mfma_f32_16x16x32_bf16 v[116:119], v[52:55], v[252:255], v[116:119]
  ds_read_b128 v[52:55], v31 offset:6400
  s_waitcnt lgkmcnt(5)
  v_mfma_f32_16x16x32_bf16 v[72:75], v[32:35], a[0:3], 0
  s_waitcnt lgkmcnt(4)
  v_mfma_f32_16x16x32_bf16 v[72:75], v[36:39], a[48:51], v[72:75]
  s_waitcnt lgkmcnt(3)
  v_mfma_f32_16x16x32_bf16 v[72:75], v[40:43], a[96:99], v[72:75]
  s_waitcnt lgkmcnt(2)
  v_mfma_f32_16x16x32_bf16 v[72:75], v[44:47], a[144:147], v[72:75]
  s_waitcnt lgkmcnt(1)
  v_mfma_f32_16x16x32_bf16 v[72:75], v[48:51], a[192:195], v[72:75]
  s_waitcnt lgkmcnt(0)
  v_mfma_f32_16x16x32_bf16 v[72:75], v[52:55], a[240:243], v[72:75]
  v_mfma_f32_16x16x32_bf16 v[76:79], v[32:35], a[4:7], 0
  v_cvt_pk_bf16_f32 v137, v112, v116
  v_mfma_f32_16x16x32_bf16 v[76:79], v[36:39], a[52:55], v[76:79]
  v_cvt_pk_bf16_f32 v139, v113, v117
  v_mfma_f32_16x16x32_bf16 v[76:79], v[40:43], a[100:103], v[76:79]
  v_cvt_pk_bf16_f32 v141, v114, v118
  v_mfma_f32_16x16x32_bf16 v[76:79], v[44:47], a[148:151], v[76:79]
  v_cvt_pk_bf16_f32 v143, v115, v119
  v_mfma_f32_16x16x32_bf16 v[76:79], v[48:51], a[196:199], v[76:79]
  v_mfma_f32_16x16x32_bf16 v[76:79], v[52:55], a[244:247], v[76:79]
  v_mfma_f32_16x16x32_bf16 v[80:83], v[32:35], a[8:11], 0
  buffer_store_dwordx2 v[136:137], v66, s[8:11], s50 offen sc0 sc1
  v_mfma_f32_16x16x32_bf16 v[80:83], v[36:39], a[56:59], v[80:83]
  buffer_store_dwordx2 v[138:139], v67, s[8:11], s50 offen sc0 sc1
  v_mfma_f32_16x16x32_bf16 v[80:83], v[40:43], a[104:107], v[80:83]
  buffer_store_dwordx2 v[140:141], v68, s[8:11], s50 offen sc0 sc1
  v_mfma_f32_16x16x32_bf16 v[80:83], v[44:47], a[152:155], v[80:83]
  buffer_store_dwordx2 v[142:143], v69, s[8:11], s50 offen sc0 sc1
  v_mfma_f32_16x16x32_bf16 v[80:83], v[48:51], a[200:203], v[80:83]
  v_mfma_f32_16x16x32_bf16 v[80:83], v[52:55], a[248:251], v[80:83]
  v_mfma_f32_16x16x32_bf16 v[84:87], v[32:35], a[12:15], 0
  s_add_u32 m0, s25, 2048
  v_xor_b32 v56, s52, v12
  v_mad_u32_u24 v56, v56, s44, v18
  buffer_load_dwordx4 v56, s[4:7], s48 offen nt lds
  v_mfma_f32_16x16x32_bf16 v[84:87], v[36:39], a[60:63], v[84:87]
  v_cvt_pk_bf16_f32 v120, v72, v76
  v_mfma_f32_16x16x32_bf16 v[84:87], v[40:43], a[108:111], v[84:87]
  v_cvt_pk_bf16_f32 v124, v73, v77
  v_mfma_f32_16x16x32_bf16 v[84:87], v[44:47], a[156:159], v[84:87]
  v_cvt_pk_bf16_f32 v128, v74, v78
  v_mfma_f32_16x16x32_bf16 v[84:87], v[48:51], a[204:207], v[84:87]
  v_cvt_pk_bf16_f32 v132, v75, v79
  v_mfma_f32_16x16x32_bf16 v[84:87], v[52:55], a[252:255], v[84:87]
  v_mfma_f32_16x16x32_bf16 v[88:91], v[32:35], a[16:19], 0
  s_add_u32 m0, s25, 3072
  v_xor_b32 v56, s52, v13
  v_mad_u32_u24 v56, v56, s44, v19
  buffer_load_dwordx4 v56, s[4:7], s48 offen nt lds
  v_mfma_f32_16x16x32_bf16 v[88:91], v[36:39], a[64:67], v[88:91]
  v_xor_b32 v57, s55, v22
  v_mad_u32_u24 v62, v57, s44, v26
  v_add_u32 v66, v62, v27
  v_mfma_f32_16x16x32_bf16 v[88:91], v[40:43], a[112:115], v[88:91]
  v_xor_b32 v57, s55, v23
  v_mad_u32_u24 v63, v57, s44, v26
  v_add_u32 v67, v63, v27
  v_mfma_f32_16x16x32_bf16 v[88:91], v[44:47], a[160:163], v[88:91]
  v_xor_b32 v57, s55, v24
  v_mad_u32_u24 v64, v57, s44, v26
  v_add_u32 v68, v64, v27
  v_mfma_f32_16x16x32_bf16 v[88:91], v[48:51], a[208:211], v[88:91]
  v_xor_b32 v57, s55, v25
  v_mad_u32_u24 v65, v57, s44, v26
  v_add_u32 v69, v65, v27
  v_mfma_f32_16x16x32_bf16 v[88:91], v[52:55], v[224:227], v[88:91]
  v_mfma_f32_16x16x32_bf16 v[92:95], v[32:35], a[20:23], 0
  v_mfma_f32_16x16x32_bf16 v[92:95], v[36:39], a[68:71], v[92:95]
  v_cvt_pk_bf16_f32 v121, v80, v84
  v_mfma_f32_16x16x32_bf16 v[92:95], v[40:43], a[116:119], v[92:95]
  v_cvt_pk_bf16_f32 v125, v81, v85
  v_mfma_f32_16x16x32_bf16 v[92:95], v[44:47], a[164:167], v[92:95]
  v_cvt_pk_bf16_f32 v129, v82, v86
  v_mfma_f32_16x16x32_bf16 v[92:95], v[48:51], a[212:215], v[92:95]
  v_cvt_pk_bf16_f32 v133, v83, v87
  v_mfma_f32_16x16x32_bf16 v[92:95], v[52:55], v[228:231], v[92:95]
  v_mfma_f32_16x16x32_bf16 v[96:99], v[32:35], a[24:27], 0
  s_add_u32 m0, s25, 4096
  v_xor_b32 v56, s52, v14
  v_mad_u32_u24 v56, v56, s44, v20
  buffer_load_dwordx4 v56, s[4:7], s48 offen nt lds
  v_mfma_f32_16x16x32_bf16 v[96:99], v[36:39], a[72:75], v[96:99]
  v_mfma_f32_16x16x32_bf16 v[96:99], v[40:43], a[120:123], v[96:99]
  v_mfma_f32_16x16x32_bf16 v[96:99], v[44:47], a[168:171], v[96:99]
  v_mfma_f32_16x16x32_bf16 v[96:99], v[48:51], a[216:219], v[96:99]
  v_mfma_f32_16x16x32_bf16 v[96:99], v[52:55], v[232:235], v[96:99]
  v_mfma_f32_16x16x32_bf16 v[100:103], v[32:35], a[28:31], 0
  s_add_u32 m0, s25, 5120
  v_xor_b32 v56, s52, v15
  v_mad_u32_u24 v56, v56, s44, v21
  buffer_load_dwordx4 v56, s[4:7], s48 offen nt lds
  v_mfma_f32_16x16x32_bf16 v[100:103], v[36:39], a[76:79], v[100:103]
  v_cvt_pk_bf16_f32 v122, v88, v92
  v_mfma_f32_16x16x32_bf16 v[100:103], v[40:43], a[124:127], v[100:103]
  v_cvt_pk_bf16_f32 v126, v89, v93
  v_mfma_f32_16x16x32_bf16 v[100:103], v[44:47], a[172:175], v[100:103]
  v_cvt_pk_bf16_f32 v130, v90, v94
  v_mfma_f32_16x16x32_bf16 v[100:103], v[48:51], a[220:223], v[100:103]
  v_cvt_pk_bf16_f32 v134, v91, v95
  v_mfma_f32_16x16x32_bf16 v[100:103], v[52:55], v[236:239], v[100:103]
  v_mfma_f32_16x16x32_bf16 v[104:107], v[32:35], a[32:35], 0
  v_mfma_f32_16x16x32_bf16 v[104:107], v[36:39], a[80:83], v[104:107]
  v_mfma_f32_16x16x32_bf16 v[104:107], v[40:43], a[128:131], v[104:107]
  v_mfma_f32_16x16x32_bf16 v[104:107], v[44:47], a[176:179], v[104:107]
  v_mfma_f32_16x16x32_bf16 v[104:107], v[48:51], a[224:227], v[104:107]
  v_mfma_f32_16x16x32_bf16 v[104:107], v[52:55], v[240:243], v[104:107]
  v_mfma_f32_16x16x32_bf16 v[108:111], v[32:35], a[36:39], 0
  v_mfma_f32_16x16x32_bf16 v[108:111], v[36:39], a[84:87], v[108:111]
  v_cvt_pk_bf16_f32 v123, v96, v100
  v_mfma_f32_16x16x32_bf16 v[108:111], v[40:43], a[132:135], v[108:111]
  v_cvt_pk_bf16_f32 v127, v97, v101
  v_mfma_f32_16x16x32_bf16 v[108:111], v[44:47], a[180:183], v[108:111]
  v_cvt_pk_bf16_f32 v131, v98, v102
  v_mfma_f32_16x16x32_bf16 v[108:111], v[48:51], a[228:231], v[108:111]
  v_cvt_pk_bf16_f32 v135, v99, v103
  v_mfma_f32_16x16x32_bf16 v[108:111], v[52:55], v[244:247], v[108:111]
  v_mfma_f32_16x16x32_bf16 v[112:115], v[32:35], a[40:43], 0
  v_mfma_f32_16x16x32_bf16 v[112:115], v[36:39], a[88:91], v[112:115]
  buffer_store_dwordx4 v[120:123], v62, s[8:11], s51 offen sc0 sc1
  v_mfma_f32_16x16x32_bf16 v[112:115], v[40:43], a[136:139], v[112:115]
  buffer_store_dwordx4 v[124:127], v63, s[8:11], s51 offen sc0 sc1
  v_mfma_f32_16x16x32_bf16 v[112:115], v[44:47], a[184:187], v[112:115]
  buffer_store_dwordx4 v[128:131], v64, s[8:11], s51 offen sc0 sc1
  v_mfma_f32_16x16x32_bf16 v[112:115], v[48:51], a[232:235], v[112:115]
  buffer_store_dwordx4 v[132:135], v65, s[8:11], s51 offen sc0 sc1
  v_mfma_f32_16x16x32_bf16 v[112:115], v[52:55], v[248:251], v[112:115]
  s_waitcnt vmcnt(4)
  v_mfma_f32_16x16x32_bf16 v[116:119], v[32:35], a[44:47], 0
  ds_read_b128 v[32:35], v30 offset:0
  v_mfma_f32_16x16x32_bf16 v[116:119], v[36:39], a[92:95], v[116:119]
  v_cvt_pk_bf16_f32 v136, v104, v108
  ds_read_b128 v[36:39], v31 offset:0
  v_mfma_f32_16x16x32_bf16 v[116:119], v[40:43], a[140:143], v[116:119]
  v_cvt_pk_bf16_f32 v138, v105, v109
  ds_read_b128 v[40:43], v30 offset:128
  v_mfma_f32_16x16x32_bf16 v[116:119], v[44:47], a[188:191], v[116:119]
  v_cvt_pk_bf16_f32 v140, v106, v110
  ds_read_b128 v[44:47], v31 offset:128
  v_mfma_f32_16x16x32_bf16 v[116:119], v[48:51], a[236:239], v[116:119]
  v_cvt_pk_bf16_f32 v142, v107, v111
  ds_read_b128 v[48:51], v30 offset:256
  v_mfma_f32_16x16x32_bf16 v[116:119], v[52:55], v[252:255], v[116:119]
  ds_read_b128 v[52:55], v31 offset:256
  s_waitcnt lgkmcnt(5)
  v_mfma_f32_16x16x32_bf16 v[72:75], v[32:35], a[0:3], 0
  s_waitcnt lgkmcnt(4)
  v_mfma_f32_16x16x32_bf16 v[72:75], v[36:39], a[48:51], v[72:75]
  s_waitcnt lgkmcnt(3)
  v_mfma_f32_16x16x32_bf16 v[72:75], v[40:43], a[96:99], v[72:75]
  s_waitcnt lgkmcnt(2)
  v_mfma_f32_16x16x32_bf16 v[72:75], v[44:47], a[144:147], v[72:75]
  s_waitcnt lgkmcnt(1)
  v_mfma_f32_16x16x32_bf16 v[72:75], v[48:51], a[192:195], v[72:75]
  s_waitcnt lgkmcnt(0)
  v_mfma_f32_16x16x32_bf16 v[72:75], v[52:55], a[240:243], v[72:75]
  v_mfma_f32_16x16x32_bf16 v[76:79], v[32:35], a[4:7], 0
  v_cvt_pk_bf16_f32 v137, v112, v116
  v_mfma_f32_16x16x32_bf16 v[76:79], v[36:39], a[52:55], v[76:79]
  v_cvt_pk_bf16_f32 v139, v113, v117
  v_mfma_f32_16x16x32_bf16 v[76:79], v[40:43], a[100:103], v[76:79]
  v_cvt_pk_bf16_f32 v141, v114, v118
  v_mfma_f32_16x16x32_bf16 v[76:79], v[44:47], a[148:151], v[76:79]
  v_cvt_pk_bf16_f32 v143, v115, v119
  v_mfma_f32_16x16x32_bf16 v[76:79], v[48:51], a[196:199], v[76:79]
  v_mfma_f32_16x16x32_bf16 v[76:79], v[52:55], a[244:247], v[76:79]
  v_mfma_f32_16x16x32_bf16 v[80:83], v[32:35], a[8:11], 0
  buffer_store_dwordx2 v[136:137], v66, s[8:11], s51 offen sc0 sc1
  v_mfma_f32_16x16x32_bf16 v[80:83], v[36:39], a[56:59], v[80:83]
  buffer_store_dwordx2 v[138:139], v67, s[8:11], s51 offen sc0 sc1
  v_mfma_f32_16x16x32_bf16 v[80:83], v[40:43], a[104:107], v[80:83]
  buffer_store_dwordx2 v[140:141], v68, s[8:11], s51 offen
  v_mfma_f32_16x16x32_bf16 v[80:83], v[44:47], a[152:155], v[80:83]
  buffer_store_dwordx2 v[142:143], v69, s[8:11], s51 offen
  v_mfma_f32_16x16x32_bf16 v[80:83], v[48:51], a[200:203], v[80:83]
  v_mfma_f32_16x16x32_bf16 v[80:83], v[52:55], a[248:251], v[80:83]
  v_mfma_f32_16x16x32_bf16 v[84:87], v[32:35], a[12:15], 0
  v_mfma_f32_16x16x32_bf16 v[84:87], v[36:39], a[60:63], v[84:87]
  v_cvt_pk_bf16_f32 v120, v72, v76
  v_mfma_f32_16x16x32_bf16 v[84:87], v[40:43], a[108:111], v[84:87]
  v_cvt_pk_bf16_f32 v124, v73, v77
  v_mfma_f32_16x16x32_bf16 v[84:87], v[44:47], a[156:159], v[84:87]
  v_cvt_pk_bf16_f32 v128, v74, v78
  v_mfma_f32_16x16x32_bf16 v[84:87], v[48:51], a[204:207], v[84:87]
  v_cvt_pk_bf16_f32 v132, v75, v79
  v_mfma_f32_16x16x32_bf16 v[84:87], v[52:55], a[252:255], v[84:87]
  v_mfma_f32_16x16x32_bf16 v[88:91], v[32:35], a[16:19], 0
  v_mfma_f32_16x16x32_bf16 v[88:91], v[36:39], a[64:67], v[88:91]
  v_xor_b32 v57, s52, v22
  v_mad_u32_u24 v62, v57, s44, v26
  v_add_u32 v66, v62, v27
  v_mfma_f32_16x16x32_bf16 v[88:91], v[40:43], a[112:115], v[88:91]
  v_xor_b32 v57, s52, v23
  v_mad_u32_u24 v63, v57, s44, v26
  v_add_u32 v67, v63, v27
  v_mfma_f32_16x16x32_bf16 v[88:91], v[44:47], a[160:163], v[88:91]
  v_xor_b32 v57, s52, v24
  v_mad_u32_u24 v64, v57, s44, v26
  v_add_u32 v68, v64, v27
  v_mfma_f32_16x16x32_bf16 v[88:91], v[48:51], a[208:211], v[88:91]
  v_xor_b32 v57, s52, v25
  v_mad_u32_u24 v65, v57, s44, v26
  v_add_u32 v69, v65, v27
  v_mfma_f32_16x16x32_bf16 v[88:91], v[52:55], v[224:227], v[88:91]
  v_mfma_f32_16x16x32_bf16 v[92:95], v[32:35], a[20:23], 0
  v_mfma_f32_16x16x32_bf16 v[92:95], v[36:39], a[68:71], v[92:95]
  v_cvt_pk_bf16_f32 v121, v80, v84
  v_mfma_f32_16x16x32_bf16 v[92:95], v[40:43], a[116:119], v[92:95]
  v_cvt_pk_bf16_f32 v125, v81, v85
  v_mfma_f32_16x16x32_bf16 v[92:95], v[44:47], a[164:167], v[92:95]
  v_cvt_pk_bf16_f32 v129, v82, v86
  v_mfma_f32_16x16x32_bf16 v[92:95], v[48:51], a[212:215], v[92:95]
  v_cvt_pk_bf16_f32 v133, v83, v87
  v_mfma_f32_16x16x32_bf16 v[92:95], v[52:55], v[228:231], v[92:95]
  v_mfma_f32_16x16x32_bf16 v[96:99], v[32:35], a[24:27], 0
  v_mfma_f32_16x16x32_bf16 v[96:99], v[36:39], a[72:75], v[96:99]
  v_mfma_f32_16x16x32_bf16 v[96:99], v[40:43], a[120:123], v[96:99]
  v_mfma_f32_16x16x32_bf16 v[96:99], v[44:47], a[168:171], v[96:99]
  v_mfma_f32_16x16x32_bf16 v[96:99], v[48:51], a[216:219], v[96:99]
  v_mfma_f32_16x16x32_bf16 v[96:99], v[52:55], v[232:235], v[96:99]
  v_mfma_f32_16x16x32_bf16 v[100:103], v[32:35], a[28:31], 0
  v_mfma_f32_16x16x32_bf16 v[100:103], v[36:39], a[76:79], v[100:103]
  v_cvt_pk_bf16_f32 v122, v88, v92
  v_mfma_f32_16x16x32_bf16 v[100:103], v[40:43], a[124:127], v[100:103]
  v_cvt_pk_bf16_f32 v126, v89, v93
  v_mfma_f32_16x16x32_bf16 v[100:103], v[44:47], a[172:175], v[100:103]
  v_cvt_pk_bf16_f32 v130, v90, v94
  v_mfma_f32_16x16x32_bf16 v[100:103], v[48:51], a[220:223], v[100:103]
  v_cvt_pk_bf16_f32 v134, v91, v95
  v_mfma_f32_16x16x32_bf16 v[100:103], v[52:55], v[236:239], v[100:103]
  v_mfma_f32_16x16x32_bf16 v[104:107], v[32:35], a[32:35], 0
  v_mfma_f32_16x16x32_bf16 v[104:107], v[36:39], a[80:83], v[104:107]
  v_mfma_f32_16x16x32_bf16 v[104:107], v[40:43], a[128:131], v[104:107]
  v_mfma_f32_16x16x32_bf16 v[104:107], v[44:47], a[176:179], v[104:107]
  v_mfma_f32_16x16x32_bf16 v[104:107], v[48:51], a[224:227], v[104:107]
  v_mfma_f32_16x16x32_bf16 v[104:107], v[52:55], v[240:243], v[104:107]
  v_mfma_f32_16x16x32_bf16 v[108:111], v[32:35], a[36:39], 0
  v_mfma_f32_16x16x32_bf16 v[108:111], v[36:39], a[84:87], v[108:111]
  v_cvt_pk_bf16_f32 v123, v96, v100
  v_mfma_f32_16x16x32_bf16 v[108:111], v[40:43], a[132:135], v[108:111]
  v_cvt_pk_bf16_f32 v127, v97, v101
  v_mfma_f32_16x16x32_bf16 v[108:111], v[44:47], a[180:183], v[108:111]
  v_cvt_pk_bf16_f32 v131, v98, v102
  v_mfma_f32_16x16x32_bf16 v[108:111], v[48:51], a[228:231], v[108:111]
  v_cvt_pk_bf16_f32 v135, v99, v103
  v_mfma_f32_16x16x32_bf16 v[108:111], v[52:55], v[244:247], v[108:111]
  v_mfma_f32_16x16x32_bf16 v[112:115], v[32:35], a[40:43], 0
  v_mfma_f32_16x16x32_bf16 v[112:115], v[36:39], a[88:91], v[112:115]
  buffer_store_dwordx4 v[120:123], v62, s[8:11], s48 offen
  v_mfma_f32_16x16x32_bf16 v[112:115], v[40:43], a[136:139], v[112:115]
  buffer_store_dwordx4 v[124:127], v63, s[8:11], s48 offen
  v_mfma_f32_16x16x32_bf16 v[112:115], v[44:47], a[184:187], v[112:115]
  buffer_store_dwordx4 v[128:131], v64, s[8:11], s48 offen
  v_mfma_f32_16x16x32_bf16 v[112:115], v[48:51], a[232:235], v[112:115]
  buffer_store_dwordx4 v[132:135], v65, s[8:11], s48 offen
  v_mfma_f32_16x16x32_bf16 v[112:115], v[52:55], v[248:251], v[112:115]
  v_mfma_f32_16x16x32_bf16 v[116:119], v[32:35], a[44:47], 0
  v_mfma_f32_16x16x32_bf16 v[116:119], v[36:39], a[92:95], v[116:119]
  v_cvt_pk_bf16_f32 v136, v104, v108
  v_mfma_f32_16x16x32_bf16 v[116:119], v[40:43], a[140:143], v[116:119]
  v_cvt_pk_bf16_f32 v138, v105, v109
  v_mfma_f32_16x16x32_bf16 v[116:119], v[44:47], a[188:191], v[116:119]
  v_cvt_pk_bf16_f32 v140, v106, v110
  v_mfma_f32_16x16x32_bf16 v[116:119], v[48:51], a[236:239], v[116:119]
  v_cvt_pk_bf16_f32 v142, v107, v111
  v_mfma_f32_16x16x32_bf16 v[116:119], v[52:55], v[252:255], v[116:119]
  s_nop 7
  v_cvt_pk_bf16_f32 v137, v112, v116
  v_cvt_pk_bf16_f32 v139, v113, v117
  v_cvt_pk_bf16_f32 v141, v114, v118
  v_cvt_pk_bf16_f32 v143, v115, v119
  buffer_store_dwordx2 v[136:137], v66, s[8:11], s48 offen
  buffer_store_dwordx2 v[138:139], v67, s[8:11], s48 offen
  buffer_store_dwordx2 v[140:141], v68, s[8:11], s48 offen
  buffer_store_dwordx2 v[142:143], v69, s[8:11], s48 offen
L_end:
  s_endpgm
L_probe_more:
L_probe_done:
  s_lshl_b32 s27, s74, s72
  s_sub_u32 s45, s58, s2
  s_and_b32 s45, s45, 7
  s_lshl_b32 s45, s45, 28
  s_cmp_eq_u32 s72, 0
  s_cselect_b32 s45, s45, 0
  s_or_b32 s27, s27, s45
  s_waitcnt lgkmcnt(0)
  s_or_b32 s60, s27, 0x80000000
  s_mov_b32 s61, 0
  s_lshl_b32 s27, s72, 2
  s_add_u32 s62, s36, s27
  s_addc_u32 s63, s37, 0
  s_atomic_cmpswap s[60:61], s[62:63], 0x0
  s_branch L_noprobe2
L_table:
  s_waitcnt lgkmcnt(0)
  s_and_b64 s[74:75], s[84:85], s[86:87]
  s_or_b64 s[72:73], s[84:85], s[86:87]
  s_and_b64 s[74:75], s[74:75], s[88:89]
  s_or_b64 s[72:73], s[72:73], s[88:89]
  s_and_b64 s[74:75], s[74:75], s[90:91]
  s_or_b64 s[72:73], s[72:73], s[90:91]
  s_and_b64 s[74:75], s[74:75], s[92:93]
  s_or_b64 s[72:73], s[72:73], s[92:93]
  s_and_b64 s[74:75], s[74:75], s[94:95]
  s_or_b64 s[72:73], s[72:73], s[94:95]
  s_and_b64 s[74:75], s[74:75], s[96:97]
  s_or_b64 s[72:73], s[72:73], s[96:97]
  s_and_b32 s74, s74, s75
  s_or_b32 s72, s72, s73
  s_mov_b32 s73, 0
  s_cmp_lt_i32 s74, 0
  s_cbranch_scc1 L_table_ok
  v_lshlrev_b32 v4, 2, v0
  v_lshlrev_b32 v6, v0, 1
  v_lshlrev_b32 v6, 14, v6
  v_or_b32 v6, 0x80000000, v6
  v_mov_b32 v7, 0
  s_mov_b64 exec, 0x3fff
L_table_poll:
  global_load_dword v5, v4, s[36:37] sc1
  s_add_u32 s73, s73, 1
  s_waitcnt vmcnt(0)
  v_cmp_eq_u32 vcc, 0, v5
  s_nop 4
  s_cbranch_vccz L_table_have
  s_cmp_lt_u32 s73, 8
  s_cbranch_scc1 L_table_poll
  global_atomic_cmpswap v5, v4, v[6:7], s[36:37] sc0
  s_waitcnt vmcnt(0)
  v_cmp_eq_u32 vcc, 0, v5
  s_nop 1
  v_cndmask_b32 v5, v5, v6, vcc
L_table_have:
  s_mov_b64 exec, -1
  s_nop 4
  v_readlane_b32 s72, v5, 0
  v_readlane_b32 s74, v5, 1
  s_nop 0
  s_or_b32 s72, s72, s74
  v_readlane_b32 s74, v5, 2
  s_nop 0
  s_or_b32 s72, s72, s74
  v_readlane_b32 s74, v5, 3
  s_nop 0
  s_or_b32 s72, s72, s74
  v_readlane_b32 s74, v5, 4
  s_nop 0
  s_or_b32 s72, s72, s74
  v_readlane_b32 s74, v5, 5
  s_nop 0
  s_or_b32 s72, s72, s74
  v_readlane_b32 s74, v5, 6
  s_nop 0
  s_or_b32 s72, s72, s74
  v_readlane_b32 s74, v5, 7
  s_nop 0
  s_or_b32 s72, s72, s74
  v_readlane_b32 s74, v5, 8
  s_nop 0
  s_or_b32 s72, s72, s74
  v_readlane_b32 s74, v5, 9
  s_nop 0
  s_or_b32 s72, s72, s74
  v_readlane_b32 s74, v5, 10
  s_nop 0
  s_or_b32 s72, s72, s74
  v_readlane_b32 s74, v5, 11
  s_nop 0
  s_or_b32 s72, s72, s74
  v_readlane_b32 s74, v5, 12
  s_nop 0
  s_or_b32 s72, s72, s74
  v_readlane_b32 s74, v5, 13
  s_nop 0
  s_or_b32 s72, s72, s74
L_table_ok:
  s_and_b32 s74, s72, 0x05555555
  s_lshl_b32 s74, s74, 1
  s_lshr_b32 s75, s72, 1
  s_and_b32 s75, s75, 0x05555555
  s_or_b32 s74, s74, s75
  s_xor_b32 s75, s72, s74
  s_and_b32 s75, s75, 0x3fff
  s_lshl_b32 s75, s75, 14
  s_and_b32 s74, s74, 0x0fffc000
  s_or_b32 s72, s72, s74
  s_or_b32 s72, s72, s75
  s_and_b32 s74, s72, 0x00ccc333
  s_lshl_b32 s74, s74, 2
  s_lshr_b32 s75, s72, 2
  s_and_b32 s75, s75, 0x00ccc333
  s_or_b32 s74, s74, s75
  s_andn2_b32 s75, s72, s74
  s_bfe_u32 s75, s75, 0xc000e
  s_andn2_b32 s72, s72, s75
  s_and_b32 s74, s74, s75
  s_or_b32 s72, s72, s74
  s_lshl_b32 s75, s75, 14
  s_andn2_b32 s72, s72, s75
  s_bfe_u32 s27, s72, 0x3001c
  s_add_u32 s27, s27, s2
  s_bfe_u32 s39, s27, 0x10002
  s_mov_b32 s40, s72
  s_branch L_table_done
L_codeend:
.section .rodata,"a"
.p2align 6
.amdhsa_kernel standalone__depthwise_separable__vision_kernel
  .amdhsa_next_free_vgpr 512
  .amdhsa_next_free_sgpr 102
  .amdhsa_accum_offset 256
  .amdhsa_group_segment_fixed_size 0
  .amdhsa_kernarg_size 48
  .amdhsa_user_sgpr_count 2
  .amdhsa_user_sgpr_kernarg_segment_ptr 1
  .amdhsa_system_sgpr_workgroup_id_x 1
  .amdhsa_float_denorm_mode_32 3
.end_amdhsa_kernel
```
